```python
import torch

def _softmax(x, axis=-1):
    return torch.softmax(x, dim=axis)
def _gelu(x):
    return torch.nn.functional.gelu(x, approximate="tanh")
def _silu(x):
    return torch.nn.functional.silu(x)
def _sigmoid(x):
    return torch.sigmoid(x)
def _layernorm(x, axis=-1, eps=1e-5):
    m = x.mean(dim=axis, keepdim=True)
    v = x.var(dim=axis, keepdim=True, unbiased=False)
    return (x - m) / torch.sqrt(v + eps)
def _scatter_add(tgt, idx, src, axis=0):
    return tgt.clone().index_add_(axis, idx, src)
def _segment_sum(src, seg, n):
    out = torch.zeros((n,) + src.shape[1:], dtype=src.dtype)
    return out.index_add_(0, seg, src)
def _pad(x, pw):
    flat = tuple(v for pair in reversed(pw) for v in pair)
    return torch.nn.functional.pad(x, flat)

kernel_name = 'interleave_layers__softmax_full_mha__mixer_channel_mlp__prompt'

def setup_inputs():

    _w = (lambda a: (lambda t: t.to(torch.bfloat16) if t.is_floating_point() else t)(torch.as_tensor(a)))
    def _A_setup():
        B, S, D = 1, 2048, 512
        return {
            "x": _w((lambda *s: torch.randn(*s, dtype=torch.bfloat16) * 0.05)(B, S, D)),
            "wqkv": _w((lambda *s: torch.randn(*s, dtype=torch.bfloat16) * 0.05)(D, 3 * D)),
            "wo": _w((lambda *s: torch.randn(*s, dtype=torch.bfloat16) * 0.05)(D, D)),
        }
    _A_in = _A_setup()

    def _B_setup():
        B, S, D, F = 1, 2048, 512, 1376
        return {
            "x": _w((lambda *s: torch.randn(*s, dtype=torch.bfloat16) * 0.05)(B, S, D)),
            "w1": _w((lambda *s: torch.randn(*s, dtype=torch.bfloat16) * 1.6)(D, F) * (D ** -0.5)),
            "b1": _w((lambda *s: torch.randn(*s, dtype=torch.bfloat16) * 0.4)(F)),
            "w2": _w((lambda *s: torch.randn(*s, dtype=torch.bfloat16) * 0.2)(F, D) * (F ** -0.5)),
            "b2": _w((lambda *s: torch.randn(*s, dtype=torch.bfloat16) * 0.2)(D)),
        }
    _B_in = _B_setup()

    return {
        "A_x": _A_in["x"],
        "A_wqkv": _A_in["wqkv"],
        "A_wo": _A_in["wo"],
        "B_x": _B_in["x"],
        "B_w1": _B_in["w1"],
        "B_b1": _B_in["b1"],
        "B_w2": _B_in["w2"],
        "B_b2": _B_in["b2"],
    }

def reference(A_x, A_wqkv, A_wo, B_x, B_w1, B_b1, B_w2, B_b2):
    def _A_ref(x, wqkv, wo):
        B, S, D = x.shape
        H = 32; Dh = D // H
        qkv = (lambda x, *d: x.permute(*d))((x @ wqkv).reshape(B, S, 3, H, Dh), 2, 0, 3, 1, 4)
        q, k, v = qkv[0], qkv[1], qkv[2]
        scale = Dh ** -0.5
        scores = torch.einsum("bhqd,bhkd->bhqk", q, k) * scale
        p = _softmax(scores, axis=-1)
        o = torch.einsum("bhqk,bhkd->bhqd", p, v)
        return (lambda x, *d: x.permute(*d))(o, 0, 2, 1, 3).reshape(B, S, D) @ wo

    def _B_ref(x, w1, b1, w2, b2):
        y = _layernorm(x, axis=-1)
        h = _gelu(torch.einsum("bsd,df->bsf", y, w1) + b1)
        return torch.einsum("bsf,fd->bsd", h, w2) + b2

    x = A_x
    x = x + _A_ref(_layernorm(x, axis=-1), A_wqkv, A_wo)
    x = x + _B_ref(_layernorm(x, axis=-1), B_w1, B_b1, B_w2, B_b2)
    x = x + _A_ref(_layernorm(x, axis=-1), A_wqkv, A_wo)
    x = x + _B_ref(_layernorm(x, axis=-1), B_w1, B_b1, B_w2, B_b2)
    return x
```

```asm
; @launch grid=(256,1,1) block=(512,1,1) lds=163840
.amdgcn_target "amdgcn-amd-amdhsa--gfx950"
.text
.globl interleave_layers__softmax_full_mha__mixer_channel_mlp__prompt_kernel
.p2align 8
.type interleave_layers__softmax_full_mha__mixer_channel_mlp__prompt_kernel,@function
interleave_layers__softmax_full_mha__mixer_channel_mlp__prompt_kernel:
    s_cmp_ge_u32 s2, 256
    s_cbranch_scc1 L_end
    s_load_dwordx16 s[12:27], s[0:1], 0
    s_load_dwordx4 s[28:31], s[0:1], 64
    s_load_dwordx2 s[32:33], s[0:1], 80
    v_lshrrev_b32 v1, 6, v0
    v_and_b32 v0, 63, v0
    v_readfirstlane_b32 s34, v1
    v_lshlrev_b32 v1, 4, v0
    v_and_b32 v252, 3, v0
    v_lshlrev_b32 v252, 3, v252
    v_bfe_u32 v5, v0, 4, 1
    v_lshl_or_b32 v252, v5, 5, v252
    v_lshrrev_b32 v5, 5, v0
    v_lshlrev_b32 v255, 4, v5
    v_and_b32 v253, 0x33, v0
    v_and_b32 v4, 4, v0
    v_lshl_or_b32 v253, v4, 1, v253
    v_and_b32 v4, 8, v0
    v_lshrrev_b32 v4, 1, v4
    v_or_b32 v253, v253, v4
    v_lshlrev_b32 v253, 4, v253
    v_and_b32 v254, 15, v0
    v_lshlrev_b32 v254, 4, v254
    v_lshl_or_b32 v254, v5, 9, v254
    v_bfe_u32 v4, v0, 4, 1
    v_lshl_or_b32 v254, v4, 17, v254
    s_and_b32 s39, s2, 7
    s_lshr_b32 s40, s2, 3
    s_and_b32 s49, s34, 3
    s_and_b32 s42, s40, 15
    s_lshr_b32 s50, s40, 4
    s_lshl_b32 s50, s50, 2
    s_add_u32 s41, s50, s49
    s_and_b32 s44, s40, 7
    s_lshr_b32 s50, s40, 3
    s_mov_b32 s47, s40
    s_lshl_b32 s43, s50, 1
    s_and_b32 s50, s34, 1
    s_add_u32 s43, s43, s50
    s_lshr_b32 s45, s49, 1
    s_lshl_b32 s46, s44, 1
    s_add_u32 s46, s46, s45
    s_mov_b32 s62, 0xffff
    s_mov_b32 s63, 0xffff
    s_mov_b32 s36, 0
    s_mov_b32 s37, 0x1000000
    s_mul_i32 s59, s39, 2097152
    s_add_u32 s37, s37, s59
    s_add_u32 s38, s37, 0x160000
    s_waitcnt lgkmcnt(0)
    s_mov_b32 s4, s32
    s_and_b32 s5, s33, 0xffff
    s_mov_b32 s6, 0x10000000
    s_mov_b32 s7, 0x20000
    s_mov_b32 s8, s12
    s_and_b32 s9, s13, 0xffff
    s_mov_b32 s10, 0x200000
    s_mov_b32 s11, 0x20000
    s_load_dword s35, s[32:33], 0
    s_cmp_ge_u32 s34, 4
    s_cbranch_scc1 L_nox_3
    v_and_b32 v4, 31, v0
    v_lshlrev_b32 v4, 10, v4
    v_add_u32 v4, v4, v255
    s_mov_b32 s50, 0x0
    s_mul_i32 s59, s39, 262144
    s_add_u32 s50, s50, s59
    s_mul_i32 s59, s43, 32768
    s_add_u32 s50, s50, s59
    s_mul_i32 s59, s46, 64
    s_add_u32 s50, s50, s59
    buffer_load_dwordx4 v[8:11], v4, s[8:11], s50 offen offset:0
    buffer_load_dwordx4 v[12:15], v4, s[8:11], s50 offen offset:32
L_nox_3:
    v_lshlrev_b32 v17, 7, v0
    s_cmp_lg_u32 s34, 6
    s_cbranch_scc1 L_nq_5
    s_mov_b32 s8, s14
    s_and_b32 s9, s15, 0xffff
    s_mov_b32 s10, 0x180000
    s_mov_b32 s11, 0x20000
    s_mul_i32 s50, s2, 6144
    v_mov_b32 v19, v17
    s_mov_b32 exec_hi, 0xffff
    buffer_load_dword v16, v19, s[8:11], s50 offen
    s_mov_b64 exec, -1
L_nq_5:
    s_cmp_lg_u32 s34, 5
    s_cbranch_scc1 L_nq_6
    s_mov_b32 s8, s14
    s_and_b32 s9, s15, 0xffff
    s_mov_b32 s10, 0x180000
    s_mov_b32 s11, 0x20000
    s_mov_b32 s50, 0x180
    s_mul_i32 s59, s40, 49152
    s_add_u32 s50, s50, s59
    v_lshlrev_b32 v19, 10, v0
    s_mov_b32 exec_hi, 0xffff
    buffer_load_dword v16, v19, s[8:11], s50 offen
    s_mov_b64 exec, -1
L_nq_6:
    s_cmp_lg_u32 s34, 4
    s_cbranch_scc1 L_npt_4
    s_add_u32 s50, s37, 0x158000
    s_mul_i32 s59, s40, 1408
    s_add_u32 s50, s50, s59
    s_mov_b64 exec, 0x7ff
    buffer_load_dword v18, v17, s[4:7], s50 offen sc1
    s_mov_b64 exec, -1
L_npt_4:
    s_cmp_ge_u32 s34, 4
    s_cbranch_scc1 L_p0end_1
    s_waitcnt lgkmcnt(0)
    s_add_u32 s35, s35, 16
    v_mov_b32 v2, s35
    v_not_b32 v3, v2
    s_getreg_b32 s57, hwreg(HW_REG_XCC_ID, 0, 4)
    s_mov_b32 s3, 1
    v_xor_b32 v3, s57, v3
    s_add_u32 s54, s37, 0x0
    s_mul_i32 s59, s43, 33792
    s_add_u32 s54, s54, s59
    s_mul_i32 s59, s46, 2048
    s_add_u32 s54, s54, s59
    s_lshr_b32 s56, s46, 2
    s_and_b32 s57, s46, 3
    s_add_u32 s55, s37, 0x158000
    s_mul_i32 s59, s43, 4096
    s_add_u32 s55, s55, s59
    s_mul_i32 s59, s56, 1024
    s_add_u32 s55, s55, s59
    s_mul_i32 s59, s57, 4
    s_add_u32 s55, s55, s59
    s_add_u32 s56, s38, 0
    s_mul_i32 s59, s43, 128
    s_add_u32 s56, s56, s59
    s_mul_i32 s59, s46, 8
    s_add_u32 s56, s56, s59
    s_cmp_lg_u32 s34, 0
    s_cbranch_scc1 L_nid_7
    s_lshl_b32 s58, s2, 7
    s_add_u32 s58, s58, 0x100000
    v_lshlrev_b32 v6, 3, v0
    s_mov_b64 exec, 0xffff
    buffer_store_dwordx2 v[2:3], v6, s[4:7], s58 offen sc1
    s_mov_b64 exec, -1
    s_waitcnt vmcnt(1)
    s_branch L_noid_2
L_nid_7:
    s_waitcnt vmcnt(0)
L_noid_2:
    v_permlane32_swap_b32 v8, v10
    v_permlane32_swap_b32 v9, v11
    v_permlane32_swap_b32 v12, v14
    v_permlane32_swap_b32 v13, v15
    s_nop 0
    v_lshlrev_b32 v66, 16, v8
    v_and_b32 v67, 0xffff0000, v8
    v_lshlrev_b32 v68, 16, v9
    v_and_b32 v69, 0xffff0000, v9
    v_lshlrev_b32 v70, 16, v10
    v_and_b32 v71, 0xffff0000, v10
    v_lshlrev_b32 v72, 16, v11
    v_and_b32 v73, 0xffff0000, v11
    v_lshlrev_b32 v74, 16, v12
    v_and_b32 v75, 0xffff0000, v12
    v_lshlrev_b32 v76, 16, v13
    v_and_b32 v77, 0xffff0000, v13
    v_lshlrev_b32 v78, 16, v14
    v_and_b32 v79, 0xffff0000, v14
    v_lshlrev_b32 v80, 16, v15
    v_and_b32 v81, 0xffff0000, v15
    s_cmp_eq_u32 s3, 0
    s_cbranch_scc1 L_wt_8
    buffer_store_dwordx4 v[8:11], v1, s[4:7], s54 offen
    buffer_store_dwordx4 v[12:15], v1, s[4:7], s54 offen offset:1024
L_wtd_9:
    v_pk_add_f32 v[84:85], v[66:67], v[68:69]
    v_pk_mul_f32 v[86:87], v[66:67], v[66:67]
    v_pk_fma_f32 v[86:87], v[68:69], v[68:69], v[86:87]
    v_pk_add_f32 v[84:85], v[84:85], v[70:71]
    v_pk_fma_f32 v[86:87], v[70:71], v[70:71], v[86:87]
    v_pk_add_f32 v[84:85], v[84:85], v[72:73]
    v_pk_fma_f32 v[86:87], v[72:73], v[72:73], v[86:87]
    v_pk_add_f32 v[84:85], v[84:85], v[74:75]
    v_pk_fma_f32 v[86:87], v[74:75], v[74:75], v[86:87]
    v_pk_add_f32 v[84:85], v[84:85], v[76:77]
    v_pk_fma_f32 v[86:87], v[76:77], v[76:77], v[86:87]
    v_pk_add_f32 v[84:85], v[84:85], v[78:79]
    v_pk_fma_f32 v[86:87], v[78:79], v[78:79], v[86:87]
    v_pk_add_f32 v[84:85], v[84:85], v[80:81]
    v_pk_fma_f32 v[86:87], v[80:81], v[80:81], v[86:87]
    v_add_f32 v84, v84, v85
    v_add_f32 v86, v86, v87
    s_nop 1
    v_permlane32_swap_b32 v84, v86
    s_nop 1
    v_add_f32 v84, v84, v86
    s_cmp_eq_u32 s3, 0
    s_cbranch_scc1 L_wt_10
    buffer_store_dword v84, v1, s[4:7], s55 offen
L_wtd_11:
    v_and_b32 v4, 15, v0
    v_lshlrev_b32 v4, 3, v4
    s_add_u32 s50, s38, 0
    s_mul_i32 s59, s41, 128
    s_add_u32 s50, s50, s59
    s_add_u32 s51, s37, 0x0
    s_mul_i32 s59, s41, 33792
    s_add_u32 s51, s51, s59
    s_add_u32 s52, s37, 0x158000
    s_mul_i32 s59, s41, 4096
    s_add_u32 s52, s52, s59
    v_add_u32 v251, 159744, v255
    v_bfe_u32 v244, v0, 2, 2
    v_lshrrev_b32 v6, 2, v255
    v_add_u32 v244, v244, v6
    v_mul_u32_u24 v244, 128, v244
    v_add_u32 v244, v244, v252
    v_bfe_u32 v6, v0, 3, 1
    v_lshl_or_b32 v244, v6, 6, v244
    v_xor_b32 v247, 64, v244
    v_bfe_u32 v245, v0, 2, 2
    v_lshrrev_b32 v6, 2, v255
    v_add_u32 v245, v245, v6
    v_mul_u32_u24 v245, 64, v245
    v_add_u32 v245, v245, v252
    v_add_u32 v245, 0x10000, v245
    s_waitcnt vmcnt(0)
    s_mov_b64 exec, 1
    s_cmp_eq_u32 s3, 0
    s_cbranch_scc1 L_wt_12
    buffer_store_dwordx2 v[2:3], off, s[4:7], s56
L_wtd_13:
    s_mov_b64 exec, -1
    s_nop 0
    v_not_b32 v3, v2
L_p0end_1:
L_layer:
    s_cmp_ge_u32 s34, 4
    s_cbranch_scc1 L_qkv_h_14
    s_cmp_lg_u32 s36, 0
    s_cbranch_scc1 L_fx_17
    v_and_b32 v6, 31, v0
    v_lshlrev_b32 v6, 10, v6
    s_mov_b32 s53, 0x100000
    s_mul_i32 s59, s39, 128
    s_add_u32 s53, s53, s59
    v_add_u32 v6, s53, v6
    v_add_u32 v7, s50, v4
    v_cmp_gt_u32 vcc, 32, v0
    s_nop 1
    v_cndmask_b32 v60, v6, v7, vcc
    s_getreg_b32 s53, hwreg(HW_REG_XCC_ID, 0, 4)
    s_mov_b32 s60, 65536
    s_mov_b32 s3, 1
L_mp_19:
    buffer_load_dwordx2 v[6:7], v60, s[4:7], 0 offen sc1
    s_waitcnt vmcnt(0)
    v_xor_b32 v7, v7, v3
    v_cmp_eq_u32 s[64:65], v6, v2
    v_cmp_eq_u32 s[66:67], s53, v7
    v_cmp_gt_u32 vcc, 16, v7
    s_nop 1
    s_and_b64 s[66:67], s[66:67], s[64:65]
    s_and_b64 vcc, vcc, s[64:65]
    s_cmp_eq_u64 s[66:67], -1
    s_cbranch_scc1 L_mpo_22
    s_cmp_eq_u32 vcc_hi, -1
    s_cbranch_scc0 L_mpok_20
    s_cmp_eq_u32 s67, -1
    s_cbranch_scc0 L_mpg_21
L_mpok_20:
    s_sub_u32 s60, s60, 1
    s_cbranch_scc0 L_mp_19
    s_endpgm
L_mpg_21:
    s_mov_b32 s3, 0
    v_xor_b32 v3, 31, v3
    s_add_u32 s54, s37, 0x0
    s_mul_i32 s59, s43, 33792
    s_add_u32 s54, s54, s59
    s_mul_i32 s59, s46, 2048
    s_add_u32 s54, s54, s59
    s_lshr_b32 s56, s46, 2
    s_and_b32 s57, s46, 3
    s_add_u32 s55, s37, 0x158000
    s_mul_i32 s59, s43, 4096
    s_add_u32 s55, s55, s59
    s_mul_i32 s59, s56, 1024
    s_add_u32 s55, s55, s59
    s_mul_i32 s59, s57, 4
    s_add_u32 s55, s55, s59
    s_add_u32 s56, s38, 0
    s_mul_i32 s59, s43, 128
    s_add_u32 s56, s56, s59
    s_mul_i32 s59, s46, 8
    s_add_u32 s56, s56, s59
    s_cmp_eq_u32 s3, 0
    s_cbranch_scc1 L_wt_23
    buffer_store_dwordx4 v[8:11], v1, s[4:7], s54 offen
    buffer_store_dwordx4 v[12:15], v1, s[4:7], s54 offen offset:1024
L_wtd_24:
    s_cmp_eq_u32 s3, 0
    s_cbranch_scc1 L_wt_25
    buffer_store_dword v84, v1, s[4:7], s55 offen
L_wtd_26:
    s_waitcnt vmcnt(0)
    s_mov_b64 exec, 1
    s_cmp_eq_u32 s3, 0
    s_cbranch_scc1 L_wt_27
    buffer_store_dwordx2 v[2:3], off, s[4:7], s56
L_wtd_28:
    s_mov_b64 exec, -1
    s_mov_b32 s60, 65536
    buffer_load_dwordx2 v[6:7], v4, s[4:7], s50 offen sc1
L_poll_29:
    buffer_load_dwordx2 v[16:17], v4, s[4:7], s50 offen sc1
    s_waitcnt vmcnt(1)
    v_cmp_eq_u64 vcc, v[6:7], v[2:3]
    s_nop 0
    s_cmp_eq_u64 vcc, -1
    s_cbranch_scc1 L_pok_30
    buffer_load_dwordx2 v[6:7], v4, s[4:7], s50 offen sc1
    s_waitcnt vmcnt(1)
    v_cmp_eq_u64 vcc, v[16:17], v[2:3]
    s_nop 0
    s_cmp_eq_u64 vcc, -1
    s_cbranch_scc1 L_pok_30
    s_sub_u32 s60, s60, 1
    s_cbranch_scc0 L_poll_29
    s_endpgm
L_pok_30:
    v_xor_b32 v3, 31, v3
L_mpo_22:
    v_mov_b32 v60, s3
    v_mov_b32 v61, 161168
    ds_write_b32 v61, v60
    s_waitcnt lgkmcnt(0)
    s_branch L_fx_18
L_fx_17:
    s_mov_b32 s60, 65536
    buffer_load_dwordx2 v[6:7], v4, s[4:7], s50 offen sc1
L_poll_31:
    buffer_load_dwordx2 v[16:17], v4, s[4:7], s50 offen sc1
    s_waitcnt vmcnt(1)
    v_cmp_eq_u64 vcc, v[6:7], v[2:3]
    s_nop 0
    s_cmp_eq_u64 vcc, -1
    s_cbranch_scc1 L_pok_32
    buffer_load_dwordx2 v[6:7], v4, s[4:7], s50 offen sc1
    s_waitcnt vmcnt(1)
    v_cmp_eq_u64 vcc, v[16:17], v[2:3]
    s_nop 0
    s_cmp_eq_u64 vcc, -1
    s_cbranch_scc1 L_pok_32
    s_sub_u32 s60, s60, 1
    s_cbranch_scc0 L_poll_31
    s_endpgm
L_pok_32:
L_fx_18:
    s_add_u32 s58, s51, 0
    buffer_load_dwordx4 v[16:19], v1, s[4:7], s58 offen offset:0 sc1
    buffer_load_dwordx4 v[20:23], v1, s[4:7], s58 offen offset:1024 sc1
    buffer_load_dwordx4 v[24:27], v1, s[4:7], s58 offen offset:2048 sc1
    buffer_load_dwordx4 v[28:31], v1, s[4:7], s58 offen offset:3072 sc1
    s_add_u32 s58, s51, 4096
    buffer_load_dwordx4 v[32:35], v1, s[4:7], s58 offen offset:0 sc1
    buffer_load_dwordx4 v[36:39], v1, s[4:7], s58 offen offset:1024 sc1
    buffer_load_dwordx4 v[40:43], v1, s[4:7], s58 offen offset:2048 sc1
    buffer_load_dwordx4 v[44:47], v1, s[4:7], s58 offen offset:3072 sc1
    s_add_u32 s58, s51, 8192
    buffer_load_dwordx4 v[48:51], v1, s[4:7], s58 offen offset:0 sc1
    buffer_load_dwordx4 v[52:55], v1, s[4:7], s58 offen offset:1024 sc1
    s_barrier
    s_bitcmp1_b32 s42, 0
    s_cbranch_scc1 L_qkv_k_16
    ds_read_b64_tr_b16 v[200:201], v245 offset:0
    ds_read_b64_tr_b16 v[202:203], v245 offset:512
    ds_read_b64_tr_b16 v[192:193], v244 offset:0
    ds_read_b64_tr_b16 v[194:195], v244 offset:1024
    ds_read_b64_tr_b16 v[196:197], v247 offset:0
    ds_read_b64_tr_b16 v[198:199], v247 offset:1024
    ds_read_b64_tr_b16 v[212:213], v245 offset:1024
    ds_read_b64_tr_b16 v[214:215], v245 offset:1536
    ds_read_b64_tr_b16 v[204:205], v244 offset:2048
    ds_read_b64_tr_b16 v[206:207], v244 offset:3072
    ds_read_b64_tr_b16 v[208:209], v247 offset:2048
    ds_read_b64_tr_b16 v[210:211], v247 offset:3072
    s_waitcnt vmcnt(9) lgkmcnt(6)
    v_mfma_f32_32x32x16_bf16 v[176:191], v[200:203], v[16:19], 0
    ds_read_b64_tr_b16 v[224:225], v245 offset:2048
    ds_read_b64_tr_b16 v[226:227], v245 offset:2560
    buffer_load_dwordx4 v[56:59], v1, s[4:7], s58 offen offset:2048 sc1
    v_mfma_f32_32x32x16_bf16 v[144:159], v[16:19], v[192:195], 0
    ds_read_b64_tr_b16 v[216:217], v244 offset:4096
    ds_read_b64_tr_b16 v[218:219], v244 offset:5120
    v_mfma_f32_32x32x16_bf16 v[160:175], v[16:19], v[196:199], 0
    ds_read_b64_tr_b16 v[220:221], v247 offset:4096
    ds_read_b64_tr_b16 v[222:223], v247 offset:5120
    s_waitcnt vmcnt(9) lgkmcnt(6)
    v_mfma_f32_32x32x16_bf16 v[176:191], v[212:215], v[20:23], v[176:191]
    ds_read_b64_tr_b16 v[200:201], v245 offset:3072
    ds_read_b64_tr_b16 v[202:203], v245 offset:3584
    buffer_load_dwordx4 v[60:63], v1, s[4:7], s58 offen offset:3072 sc1
    v_mfma_f32_32x32x16_bf16 v[144:159], v[20:23], v[204:207], v[144:159]
    ds_read_b64_tr_b16 v[192:193], v244 offset:6144
    ds_read_b64_tr_b16 v[194:195], v244 offset:7168
    v_mfma_f32_32x32x16_bf16 v[160:175], v[20:23], v[208:211], v[160:175]
    ds_read_b64_tr_b16 v[196:197], v247 offset:6144
    ds_read_b64_tr_b16 v[198:199], v247 offset:7168
    s_waitcnt vmcnt(9) lgkmcnt(6)
    v_mfma_f32_32x32x16_bf16 v[176:191], v[224:227], v[24:27], v[176:191]
    ds_read_b64_tr_b16 v[212:213], v245 offset:4096
    ds_read_b64_tr_b16 v[214:215], v245 offset:4608
    s_add_u32 s58, s51, 12288
    buffer_load_dwordx4 v[64:67], v1, s[4:7], s58 offen offset:0 sc1
    v_mfma_f32_32x32x16_bf16 v[144:159], v[24:27], v[216:219], v[144:159]
    ds_read_b64_tr_b16 v[204:205], v244 offset:8192
    ds_read_b64_tr_b16 v[206:207], v244 offset:9216
    v_mfma_f32_32x32x16_bf16 v[160:175], v[24:27], v[220:223], v[160:175]
    ds_read_b64_tr_b16 v[208:209], v247 offset:8192
    ds_read_b64_tr_b16 v[210:211], v247 offset:9216
    s_waitcnt vmcnt(9) lgkmcnt(6)
    v_mfma_f32_32x32x16_bf16 v[176:191], v[200:203], v[28:31], v[176:191]
    ds_read_b64_tr_b16 v[224:225], v245 offset:5120
    ds_read_b64_tr_b16 v[226:227], v245 offset:5632
    buffer_load_dwordx4 v[68:71], v1, s[4:7], s58 offen offset:1024 sc1
    v_mfma_f32_32x32x16_bf16 v[144:159], v[28:31], v[192:195], v[144:159]
    ds_read_b64_tr_b16 v[216:217], v244 offset:10240
    ds_read_b64_tr_b16 v[218:219], v244 offset:11264
    buffer_load_dwordx4 v[228:231], v1, s[4:7], s52 offen offset:0 sc1
    v_mfma_f32_32x32x16_bf16 v[160:175], v[28:31], v[196:199], v[160:175]
    ds_read_b64_tr_b16 v[220:221], v247 offset:10240
    ds_read_b64_tr_b16 v[222:223], v247 offset:11264
    s_waitcnt vmcnt(10) lgkmcnt(6)
    v_mfma_f32_32x32x16_bf16 v[176:191], v[212:215], v[32:35], v[176:191]
    ds_read_b64_tr_b16 v[200:201], v245 offset:6144
    ds_read_b64_tr_b16 v[202:203], v245 offset:6656
    buffer_load_dwordx4 v[72:75], v1, s[4:7], s58 offen offset:2048 sc1
    v_mfma_f32_32x32x16_bf16 v[144:159], v[32:35], v[204:207], v[144:159]
    ds_read_b64_tr_b16 v[192:193], v244 offset:12288
    ds_read_b64_tr_b16 v[194:195], v244 offset:13312
    v_mfma_f32_32x32x16_bf16 v[160:175], v[32:35], v[208:211], v[160:175]
    ds_read_b64_tr_b16 v[196:197], v247 offset:12288
    ds_read_b64_tr_b16 v[198:199], v247 offset:13312
    s_waitcnt vmcnt(10) lgkmcnt(6)
    v_mfma_f32_32x32x16_bf16 v[176:191], v[224:227], v[36:39], v[176:191]
    ds_read_b64_tr_b16 v[212:213], v245 offset:7168
    ds_read_b64_tr_b16 v[214:215], v245 offset:7680
    buffer_load_dwordx4 v[76:79], v1, s[4:7], s58 offen offset:3072 sc1
    v_mfma_f32_32x32x16_bf16 v[144:159], v[36:39], v[216:219], v[144:159]
    ds_read_b64_tr_b16 v[204:205], v244 offset:14336
    ds_read_b64_tr_b16 v[206:207], v244 offset:15360
    buffer_load_dwordx4 v[232:235], v1, s[4:7], s52 offen offset:1024 sc1
    v_mfma_f32_32x32x16_bf16 v[160:175], v[36:39], v[220:223], v[160:175]
    ds_read_b64_tr_b16 v[208:209], v247 offset:14336
    ds_read_b64_tr_b16 v[210:211], v247 offset:15360
    s_waitcnt vmcnt(11) lgkmcnt(6)
    v_mfma_f32_32x32x16_bf16 v[176:191], v[200:203], v[40:43], v[176:191]
    ds_read_b64_tr_b16 v[224:225], v245 offset:8192
    ds_read_b64_tr_b16 v[226:227], v245 offset:8704
    s_add_u32 s58, s51, 16384
    buffer_load_dwordx4 v[80:83], v1, s[4:7], s58 offen offset:0 sc1
    v_mfma_f32_32x32x16_bf16 v[144:159], v[40:43], v[192:195], v[144:159]
    ds_read_b64_tr_b16 v[216:217], v244 offset:16384
    ds_read_b64_tr_b16 v[218:219], v244 offset:17408
    v_mfma_f32_32x32x16_bf16 v[160:175], v[40:43], v[196:199], v[160:175]
    ds_read_b64_tr_b16 v[220:221], v247 offset:16384
    ds_read_b64_tr_b16 v[222:223], v247 offset:17408
    s_waitcnt vmcnt(11) lgkmcnt(6)
    v_mfma_f32_32x32x16_bf16 v[176:191], v[212:215], v[44:47], v[176:191]
    ds_read_b64_tr_b16 v[200:201], v245 offset:9216
    ds_read_b64_tr_b16 v[202:203], v245 offset:9728
    buffer_load_dwordx4 v[84:87], v1, s[4:7], s58 offen offset:1024 sc1
    v_mfma_f32_32x32x16_bf16 v[144:159], v[44:47], v[204:207], v[144:159]
    ds_read_b64_tr_b16 v[192:193], v244 offset:18432
    ds_read_b64_tr_b16 v[194:195], v244 offset:19456
    buffer_load_dwordx4 v[236:239], v1, s[4:7], s52 offen offset:2048 sc1
    v_mfma_f32_32x32x16_bf16 v[160:175], v[44:47], v[208:211], v[160:175]
    ds_read_b64_tr_b16 v[196:197], v247 offset:18432
    ds_read_b64_tr_b16 v[198:199], v247 offset:19456
    s_waitcnt vmcnt(12) lgkmcnt(6)
    v_mfma_f32_32x32x16_bf16 v[176:191], v[224:227], v[48:51], v[176:191]
    ds_read_b64_tr_b16 v[212:213], v245 offset:10240
    ds_read_b64_tr_b16 v[214:215], v245 offset:10752
    buffer_load_dwordx4 v[88:91], v1, s[4:7], s58 offen offset:2048 sc1
    v_mfma_f32_32x32x16_bf16 v[144:159], v[48:51], v[216:219], v[144:159]
    ds_read_b64_tr_b16 v[204:205], v244 offset:20480
    ds_read_b64_tr_b16 v[206:207], v244 offset:21504
    v_mfma_f32_32x32x16_bf16 v[160:175], v[48:51], v[220:223], v[160:175]
    ds_read_b64_tr_b16 v[208:209], v247 offset:20480
    ds_read_b64_tr_b16 v[210:211], v247 offset:21504
    s_waitcnt vmcnt(12) lgkmcnt(6)
    v_mfma_f32_32x32x16_bf16 v[176:191], v[200:203], v[52:55], v[176:191]
    ds_read_b64_tr_b16 v[224:225], v245 offset:11264
    ds_read_b64_tr_b16 v[226:227], v245 offset:11776
    buffer_load_dwordx4 v[92:95], v1, s[4:7], s58 offen offset:3072 sc1
    v_mfma_f32_32x32x16_bf16 v[144:159], v[52:55], v[192:195], v[144:159]
    ds_read_b64_tr_b16 v[216:217], v244 offset:22528
    ds_read_b64_tr_b16 v[218:219], v244 offset:23552
    buffer_load_dwordx4 v[240:243], v1, s[4:7], s52 offen offset:3072 sc1
    v_mfma_f32_32x32x16_bf16 v[160:175], v[52:55], v[196:199], v[160:175]
    ds_read_b64_tr_b16 v[220:221], v247 offset:22528
    ds_read_b64_tr_b16 v[222:223], v247 offset:23552
    s_waitcnt vmcnt(13) lgkmcnt(6)
    v_mfma_f32_32x32x16_bf16 v[176:191], v[212:215], v[56:59], v[176:191]
    ds_read_b64_tr_b16 v[200:201], v245 offset:12288
    ds_read_b64_tr_b16 v[202:203], v245 offset:12800
    s_add_u32 s58, s51, 20480
    buffer_load_dwordx4 v[96:99], v1, s[4:7], s58 offen offset:0 sc1
    s_lshr_b32 s50, s42, 1
    s_mov_b32 s54, 0x200000
    v_mfma_f32_32x32x16_bf16 v[144:159], v[56:59], v[204:207], v[144:159]
    ds_read_b64_tr_b16 v[192:193], v244 offset:24576
    ds_read_b64_tr_b16 v[194:195], v244 offset:25600
    s_mul_i32 s59, s36, 4194304
    s_add_u32 s54, s54, s59
    v_mfma_f32_32x32x16_bf16 v[160:175], v[56:59], v[208:211], v[160:175]
    ds_read_b64_tr_b16 v[196:197], v247 offset:24576
    ds_read_b64_tr_b16 v[198:199], v247 offset:25600
    s_mul_i32 s59, s50, 524288
    s_add_u32 s54, s54, s59
    s_waitcnt vmcnt(13) lgkmcnt(6)
    v_mfma_f32_32x32x16_bf16 v[176:191], v[224:227], v[60:63], v[176:191]
    ds_read_b64_tr_b16 v[212:213], v245 offset:13312
    ds_read_b64_tr_b16 v[214:215], v245 offset:13824
    buffer_load_dwordx4 v[100:103], v1, s[4:7], s58 offen offset:1024 sc1
    s_mul_i32 s59, s39, 16384
    s_add_u32 s54, s54, s59
    v_mfma_f32_32x32x16_bf16 v[144:159], v[60:63], v[216:219], v[144:159]
    ds_read_b64_tr_b16 v[204:205], v244 offset:26624
    ds_read_b64_tr_b16 v[206:207], v244 offset:27648
    s_mul_i32 s59, s41, 2048
    s_add_u32 s54, s54, s59
    v_mfma_f32_32x32x16_bf16 v[160:175], v[60:63], v[220:223], v[160:175]
    ds_read_b64_tr_b16 v[208:209], v247 offset:26624
    ds_read_b64_tr_b16 v[210:211], v247 offset:27648
    s_add_u32 s52, s37, 0x98000
    s_mul_i32 s59, s50, 8192
    s_waitcnt vmcnt(13) lgkmcnt(6)
    v_mfma_f32_32x32x16_bf16 v[176:191], v[200:203], v[64:67], v[176:191]
    ds_read_b64_tr_b16 v[224:225], v245 offset:14336
    ds_read_b64_tr_b16 v[226:227], v245 offset:14848
    buffer_load_dwordx4 v[104:107], v1, s[4:7], s58 offen offset:2048 sc1
    s_add_u32 s52, s52, s59
    s_mul_i32 s59, s41, 99328
    v_mfma_f32_32x32x16_bf16 v[144:159], v[64:67], v[192:195], v[144:159]
    ds_read_b64_tr_b16 v[216:217], v244 offset:28672
    ds_read_b64_tr_b16 v[218:219], v244 offset:29696
    s_add_u32 s52, s52, s59
    s_add_u32 s56, s38, 1024
    v_mfma_f32_32x32x16_bf16 v[160:175], v[64:67], v[196:199], v[160:175]
    ds_read_b64_tr_b16 v[220:221], v247 offset:28672
    ds_read_b64_tr_b16 v[222:223], v247 offset:29696
    s_mul_i32 s59, s42, 64
    s_add_u32 s56, s56, s59
    s_waitcnt vmcnt(13) lgkmcnt(6)
    v_mfma_f32_32x32x16_bf16 v[176:191], v[212:215], v[68:71], v[176:191]
    ds_read_b64_tr_b16 v[200:201], v245 offset:15360
    ds_read_b64_tr_b16 v[202:203], v245 offset:15872
    buffer_load_dwordx4 v[108:111], v1, s[4:7], s58 offen offset:3072 sc1
    s_mul_i32 s59, s41, 8
    s_add_u32 s56, s56, s59
    v_mfma_f32_32x32x16_bf16 v[144:159], v[68:71], v[204:207], v[144:159]
    ds_read_b64_tr_b16 v[192:193], v244 offset:30720
    ds_read_b64_tr_b16 v[194:195], v244 offset:31744
    s_mov_b32 s57, 0xa00000
    s_mul_i32 s59, s36, 1048576
    v_mfma_f32_32x32x16_bf16 v[160:175], v[68:71], v[208:211], v[160:175]
    ds_read_b64_tr_b16 v[196:197], v247 offset:30720
    ds_read_b64_tr_b16 v[198:199], v247 offset:31744
    s_add_u32 s57, s57, s59
    s_mul_i32 s59, s42, 65536
    s_waitcnt vmcnt(12) lgkmcnt(6)
    v_mfma_f32_32x32x16_bf16 v[176:191], v[224:227], v[72:75], v[176:191]
    s_add_u32 s58, s51, 24576
    buffer_load_dwordx4 v[112:115], v1, s[4:7], s58 offen offset:0 sc1
    s_add_u32 s57, s57, s59
    s_mul_i32 s59, s39, 8192
    v_mfma_f32_32x32x16_bf16 v[144:159], v[72:75], v[216:219], v[144:159]
    ds_read_b64_tr_b16 v[204:205], v244 offset:32768
    ds_read_b64_tr_b16 v[206:207], v244 offset:33792
    s_add_u32 s57, s57, s59
    s_mul_i32 s59, s41, 1024
    v_mfma_f32_32x32x16_bf16 v[160:175], v[72:75], v[220:223], v[160:175]
    ds_read_b64_tr_b16 v[208:209], v247 offset:32768
    ds_read_b64_tr_b16 v[210:211], v247 offset:33792
    s_add_u32 s57, s57, s59
    s_add_u32 s53, s37, 0x90000
    s_waitcnt vmcnt(12) lgkmcnt(4)
    v_mfma_f32_32x32x16_bf16 v[176:191], v[200:203], v[76:79], v[176:191]
    buffer_load_dwordx4 v[116:119], v1, s[4:7], s58 offen offset:1024 sc1
    s_mul_i32 s59, s42, 2048
    s_add_u32 s53, s53, s59
    v_mfma_f32_32x32x16_bf16 v[144:159], v[76:79], v[192:195], v[144:159]
    ds_read_b64_tr_b16 v[216:217], v244 offset:34816
    ds_read_b64_tr_b16 v[218:219], v244 offset:35840
    s_mul_i32 s59, s41, 99328
    s_add_u32 s53, s53, s59
    v_mfma_f32_32x32x16_bf16 v[160:175], v[76:79], v[196:199], v[160:175]
    ds_read_b64_tr_b16 v[220:221], v247 offset:34816
    ds_read_b64_tr_b16 v[222:223], v247 offset:35840
    v_and_b32 v4, 31, v0
    v_lshlrev_b32 v4, 2, v4
    s_barrier
    s_waitcnt vmcnt(11) lgkmcnt(4)
    v_mfma_f32_32x32x16_bf16 v[144:159], v[80:83], v[204:207], v[144:159]
    ds_read_b64_tr_b16 v[192:193], v244 offset:36864
    ds_read_b64_tr_b16 v[194:195], v244 offset:37888
    buffer_load_dwordx4 v[120:123], v1, s[4:7], s58 offen offset:2048 sc1
    s_mov_b32 s50, 0x27600
    s_mul_i32 s59, s49, 256
    v_mfma_f32_32x32x16_bf16 v[160:175], v[80:83], v[208:211], v[160:175]
    ds_read_b64_tr_b16 v[196:197], v247 offset:36864
    ds_read_b64_tr_b16 v[198:199], v247 offset:37888
    s_add_u32 s50, s50, s59
    v_add_u32 v6, s50, v4
    s_waitcnt vmcnt(11) lgkmcnt(4)
    v_mfma_f32_32x32x16_bf16 v[144:159], v[84:87], v[216:219], v[144:159]
    ds_read_b64_tr_b16 v[204:205], v244 offset:38912
    ds_read_b64_tr_b16 v[206:207], v244 offset:39936
    buffer_load_dwordx4 v[124:127], v1, s[4:7], s58 offen offset:3072 sc1
    v_add_u32 v7, s50, v255
    v_add_u32 v4, 159744, v4
    v_mfma_f32_32x32x16_bf16 v[160:175], v[84:87], v[220:223], v[160:175]
    ds_read_b64_tr_b16 v[208:209], v247 offset:38912
    ds_read_b64_tr_b16 v[210:211], v247 offset:39936
    s_waitcnt vmcnt(8) lgkmcnt(4)
    v_mfma_f32_32x32x16_bf16 v[144:159], v[88:91], v[192:195], v[144:159]
    ds_read_b64_tr_b16 v[216:217], v244 offset:40960
    ds_read_b64_tr_b16 v[218:219], v244 offset:41984
    s_add_u32 s58, s51, 28672
    buffer_load_dwordx4 v[128:131], v1, s[4:7], s58 offen offset:0 sc1
    v_add_f32 v228, v228, v229
    v_add_f32 v228, v228, v230
    v_mfma_f32_32x32x16_bf16 v[160:175], v[88:91], v[196:199], v[160:175]
    ds_read_b64_tr_b16 v[220:221], v247 offset:40960
    ds_read_b64_tr_b16 v[222:223], v247 offset:41984
    v_add_f32 v228, v228, v231
    v_add_f32 v228, v228, v232
    s_waitcnt vmcnt(9) lgkmcnt(4)
    v_mfma_f32_32x32x16_bf16 v[144:159], v[92:95], v[204:207], v[144:159]
    ds_read_b64_tr_b16 v[192:193], v244 offset:43008
    ds_read_b64_tr_b16 v[194:195], v244 offset:44032
    buffer_load_dwordx4 v[132:135], v1, s[4:7], s58 offen offset:1024 sc1
    v_add_f32 v228, v228, v233
    v_add_f32 v228, v228, v234
    v_mfma_f32_32x32x16_bf16 v[160:175], v[92:95], v[208:211], v[160:175]
    ds_read_b64_tr_b16 v[196:197], v247 offset:43008
    ds_read_b64_tr_b16 v[198:199], v247 offset:44032
    v_add_f32 v228, v228, v235
    v_add_f32 v228, v228, v236
    s_waitcnt vmcnt(9) lgkmcnt(4)
    v_mfma_f32_32x32x16_bf16 v[144:159], v[96:99], v[216:219], v[144:159]
    ds_read_b64_tr_b16 v[204:205], v244 offset:45056
    ds_read_b64_tr_b16 v[206:207], v244 offset:46080
    buffer_load_dwordx4 v[136:139], v1, s[4:7], s58 offen offset:2048 sc1
    v_add_f32 v228, v228, v237
    v_add_f32 v228, v228, v238
    v_mfma_f32_32x32x16_bf16 v[160:175], v[96:99], v[220:223], v[160:175]
    ds_read_b64_tr_b16 v[208:209], v247 offset:45056
    ds_read_b64_tr_b16 v[210:211], v247 offset:46080
    v_add_f32 v228, v228, v239
    v_add_f32 v228, v228, v240
    s_waitcnt vmcnt(9) lgkmcnt(4)
    v_mfma_f32_32x32x16_bf16 v[144:159], v[100:103], v[192:195], v[144:159]
    ds_read_b64_tr_b16 v[216:217], v244 offset:47104
    ds_read_b64_tr_b16 v[218:219], v244 offset:48128
    buffer_load_dwordx4 v[140:143], v1, s[4:7], s58 offen offset:3072 sc1
    v_add_f32 v228, v228, v241
    v_add_f32 v228, v228, v242
    v_mfma_f32_32x32x16_bf16 v[160:175], v[100:103], v[196:199], v[160:175]
    ds_read_b64_tr_b16 v[220:221], v247 offset:47104
    ds_read_b64_tr_b16 v[222:223], v247 offset:48128
    v_add_f32 v228, v228, v243
    v_mov_b32 v229, v228
    s_barrier
    s_waitcnt vmcnt(9) lgkmcnt(4)
    v_mfma_f32_32x32x16_bf16 v[144:159], v[104:107], v[204:207], v[144:159]
    ds_read_b64_tr_b16 v[192:193], v244 offset:49152
    ds_read_b64_tr_b16 v[194:195], v244 offset:50176
    s_nop 1
    v_permlane32_swap_b32 v228, v229
    v_mfma_f32_32x32x16_bf16 v[160:175], v[104:107], v[208:211], v[160:175]
    ds_read_b64_tr_b16 v[196:197], v247 offset:49152
    ds_read_b64_tr_b16 v[198:199], v247 offset:50176
    s_nop 1
    v_mul_f32 v246, 0x3b000000, v228
    s_waitcnt vmcnt(8) lgkmcnt(4)
    v_mfma_f32_32x32x16_bf16 v[144:159], v[108:111], v[216:219], v[144:159]
    ds_read_b64_tr_b16 v[204:205], v244 offset:51200
    ds_read_b64_tr_b16 v[206:207], v244 offset:52224
    v_mul_f32 v229, 0x3b000000, v229
    v_fma_f32 v229, -v246, v246, v229
    v_mfma_f32_32x32x16_bf16 v[160:175], v[108:111], v[220:223], v[160:175]
    ds_read_b64_tr_b16 v[208:209], v247 offset:51200
    ds_read_b64_tr_b16 v[210:211], v247 offset:52224
    v_max_f32 v229, 0, v229
    v_add_f32 v230, 0x3727c5ac, v229
    s_waitcnt vmcnt(7) lgkmcnt(4)
    v_mfma_f32_32x32x16_bf16 v[144:159], v[112:115], v[192:195], v[144:159]
    ds_read_b64_tr_b16 v[216:217], v244 offset:53248
    ds_read_b64_tr_b16 v[218:219], v244 offset:54272
    v_rsq_f32 v248, v230
    s_nop 0
    v_mfma_f32_32x32x16_bf16 v[160:175], v[112:115], v[196:199], v[160:175]
    ds_read_b64_tr_b16 v[220:221], v247 offset:53248
    ds_read_b64_tr_b16 v[222:223], v247 offset:54272
    v_mul_f32 v250, 0x3eb8aa3b, v248
    ds_write_b32 v6, v246
    s_waitcnt vmcnt(6) lgkmcnt(5)
    v_mfma_f32_32x32x16_bf16 v[144:159], v[116:119], v[204:207], v[144:159]
    ds_read_b64_tr_b16 v[192:193], v244 offset:55296
    ds_read_b64_tr_b16 v[194:195], v244 offset:56320
    ds_write_b32 v6, v248 offset:128
    ds_read_b128 v[32:35], v7 offset:0
    v_mfma_f32_32x32x16_bf16 v[160:175], v[116:119], v[208:211], v[160:175]
    ds_read_b64_tr_b16 v[196:197], v247 offset:55296
    ds_read_b64_tr_b16 v[198:199], v247 offset:56320
    ds_read_b128 v[36:39], v7 offset:32
    ds_read_b128 v[40:43], v7 offset:64
    s_waitcnt vmcnt(5) lgkmcnt(9)
    v_mfma_f32_32x32x16_bf16 v[144:159], v[120:123], v[216:219], v[144:159]
    ds_read_b64_tr_b16 v[204:205], v244 offset:57344
    ds_read_b64_tr_b16 v[206:207], v244 offset:58368
    ds_read_b128 v[44:47], v7 offset:96
    ds_read_b128 v[48:51], v7 offset:128
    v_mfma_f32_32x32x16_bf16 v[160:175], v[120:123], v[220:223], v[160:175]
    ds_read_b64_tr_b16 v[208:209], v247 offset:57344
    ds_read_b64_tr_b16 v[210:211], v247 offset:58368
    ds_read_b128 v[52:55], v7 offset:160
    ds_read_b128 v[56:59], v7 offset:192
    s_waitcnt vmcnt(4) lgkmcnt(10)
    v_mfma_f32_32x32x16_bf16 v[144:159], v[124:127], v[192:195], v[144:159]
    ds_read_b64_tr_b16 v[216:217], v244 offset:59392
    ds_read_b64_tr_b16 v[218:219], v244 offset:60416
    ds_read_b128 v[60:63], v7 offset:224
    ds_read_b32 v64, v4 offset:0
    v_mfma_f32_32x32x16_bf16 v[160:175], v[124:127], v[196:199], v[160:175]
    ds_read_b64_tr_b16 v[220:221], v247 offset:59392
    ds_read_b64_tr_b16 v[222:223], v247 offset:60416
    ds_read_b32 v65, v4 offset:128
    s_waitcnt vmcnt(3) lgkmcnt(9)
    v_mfma_f32_32x32x16_bf16 v[144:159], v[128:131], v[204:207], v[144:159]
    ds_read_b64_tr_b16 v[192:193], v244 offset:61440
    ds_read_b64_tr_b16 v[194:195], v244 offset:62464
    v_mfma_f32_32x32x16_bf16 v[160:175], v[128:131], v[208:211], v[160:175]
    ds_read_b64_tr_b16 v[196:197], v247 offset:61440
    ds_read_b64_tr_b16 v[198:199], v247 offset:62464
    s_waitcnt vmcnt(2) lgkmcnt(5)
    v_mfma_f32_32x32x16_bf16 v[144:159], v[132:135], v[216:219], v[144:159]
    ds_read_b64_tr_b16 v[204:205], v244 offset:63488
    ds_read_b64_tr_b16 v[206:207], v244 offset:64512
    v_mfma_f32_32x32x16_bf16 v[160:175], v[132:135], v[220:223], v[160:175]
    ds_read_b64_tr_b16 v[208:209], v247 offset:63488
    ds_read_b64_tr_b16 v[210:211], v247 offset:64512
    s_waitcnt vmcnt(1) lgkmcnt(4)
    v_mfma_f32_32x32x16_bf16 v[144:159], v[136:139], v[192:195], v[144:159]
    ds_read_b64_tr_b16 v[200:201], v245 offset:16384
    ds_read_b64_tr_b16 v[202:203], v245 offset:16896
    v_mfma_f32_32x32x16_bf16 v[160:175], v[136:139], v[196:199], v[160:175]
    ds_read_b64_tr_b16 v[212:213], v245 offset:17408
    ds_read_b64_tr_b16 v[214:215], v245 offset:17920
    s_waitcnt vmcnt(0) lgkmcnt(4)
    v_mfma_f32_32x32x16_bf16 v[144:159], v[140:143], v[204:207], v[144:159]
    ds_read_b64_tr_b16 v[224:225], v245 offset:18432
    ds_read_b64_tr_b16 v[226:227], v245 offset:18944
    v_mfma_f32_32x32x16_bf16 v[160:175], v[140:143], v[208:211], v[160:175]
    s_waitcnt lgkmcnt(4)
    v_mfma_f32_32x32x16_bf16 v[176:191], v[200:203], v[80:83], v[176:191]
    ds_read_b64_tr_b16 v[192:193], v245 offset:19456
    ds_read_b64_tr_b16 v[194:195], v245 offset:19968
    ds_read_b64_tr_b16 v[196:197], v245 offset:20480
    ds_read_b64_tr_b16 v[198:199], v245 offset:20992
    ds_read_b128 v[228:231], v251 offset:256
    ds_read_b128 v[232:235], v251 offset:288
    ds_read_b128 v[236:239], v251 offset:320
    ds_read_b128 v[240:243], v251 offset:352
    s_add_u32 s55, s54, 0x40000
    s_waitcnt lgkmcnt(10)
    v_mfma_f32_32x32x16_bf16 v[176:191], v[212:215], v[84:87], v[176:191]
    ds_read_b64_tr_b16 v[204:205], v245 offset:21504
    ds_read_b64_tr_b16 v[206:207], v245 offset:22016
    ds_read_b64_tr_b16 v[208:209], v245 offset:22528
    ds_read_b64_tr_b16 v[210:211], v245 offset:23040
    s_add_u32 s50, s52, 4096
    v_and_b32 v7, 0x1ffff, v254
    v_lshrrev_b32 v6, 17, v254
    v_lshl_or_b32 v7, v6, 11, v7
    v_fma_f32 v144, -v32, v64, v144
    v_fma_f32 v145, -v33, v64, v145
    s_waitcnt lgkmcnt(12)
    v_mfma_f32_32x32x16_bf16 v[176:191], v[224:227], v[88:91], v[176:191]
    ds_read_b64_tr_b16 v[216:217], v245 offset:23552
    ds_read_b64_tr_b16 v[218:219], v245 offset:24064
    v_fma_f32 v146, -v34, v64, v146
    v_fma_f32 v147, -v35, v64, v147
    v_fma_f32 v148, -v36, v64, v148
    v_fma_f32 v149, -v37, v64, v149
    v_fma_f32 v150, -v38, v64, v150
    v_fma_f32 v151, -v39, v64, v151
    s_waitcnt lgkmcnt(12)
    v_mfma_f32_32x32x16_bf16 v[176:191], v[192:195], v[92:95], v[176:191]
    ds_read_b64_tr_b16 v[220:221], v245 offset:24576
    ds_read_b64_tr_b16 v[222:223], v245 offset:25088
    v_fma_f32 v152, -v40, v64, v152
    v_fma_f32 v153, -v41, v64, v153
    v_fma_f32 v154, -v42, v64, v154
    v_fma_f32 v155, -v43, v64, v155
    v_fma_f32 v156, -v44, v64, v156
    v_fma_f32 v157, -v45, v64, v157
    s_waitcnt lgkmcnt(6)
    v_mfma_f32_32x32x16_bf16 v[176:191], v[196:199], v[96:99], v[176:191]
    ds_read_b64_tr_b16 v[200:201], v245 offset:25600
    ds_read_b64_tr_b16 v[202:203], v245 offset:26112
    v_fma_f32 v158, -v46, v64, v158
    v_fma_f32 v159, -v47, v64, v159
    v_mul_f32 v144, v48, v144
    v_mul_f32 v145, v49, v145
    v_mul_f32 v146, v50, v146
    v_mul_f32 v147, v51, v147
    v_mfma_f32_32x32x16_bf16 v[176:191], v[204:207], v[100:103], v[176:191]
    ds_read_b64_tr_b16 v[212:213], v245 offset:26624
    ds_read_b64_tr_b16 v[214:215], v245 offset:27136
    v_mul_f32 v148, v52, v148
    v_mul_f32 v149, v53, v149
    v_mul_f32 v150, v54, v150
    v_mul_f32 v151, v55, v151
    v_mul_f32 v152, v56, v152
    v_mul_f32 v153, v57, v153
    s_waitcnt lgkmcnt(6)
    v_mfma_f32_32x32x16_bf16 v[176:191], v[208:211], v[104:107], v[176:191]
    ds_read_b64_tr_b16 v[224:225], v245 offset:27648
    ds_read_b64_tr_b16 v[226:227], v245 offset:28160
    v_mul_f32 v154, v58, v154
    v_mul_f32 v155, v59, v155
    v_mul_f32 v156, v60, v156
    v_mul_f32 v157, v61, v157
    v_mul_f32 v158, v62, v158
    v_mul_f32 v159, v63, v159
    v_mfma_f32_32x32x16_bf16 v[176:191], v[216:219], v[108:111], v[176:191]
    ds_read_b64_tr_b16 v[192:193], v245 offset:28672
    ds_read_b64_tr_b16 v[194:195], v245 offset:29184
    v_cvt_pk_bf16_f32 v16, v144, v145
    v_cvt_pk_bf16_f32 v17, v146, v147
    v_cvt_pk_bf16_f32 v18, v148, v149
    v_cvt_pk_bf16_f32 v19, v150, v151
    v_cvt_pk_bf16_f32 v20, v152, v153
    v_cvt_pk_bf16_f32 v21, v154, v155
    s_waitcnt lgkmcnt(6)
    v_mfma_f32_32x32x16_bf16 v[176:191], v[220:223], v[112:115], v[176:191]
    ds_read_b64_tr_b16 v[196:197], v245 offset:29696
    ds_read_b64_tr_b16 v[198:199], v245 offset:30208
    v_cvt_pk_bf16_f32 v22, v156, v157
    v_cvt_pk_bf16_f32 v23, v158, v159
    buffer_store_dwordx4 v[16:19], v254, s[4:7], s54 offen offset:1024 sc1
    buffer_store_dwordx4 v[20:23], v254, s[4:7], s54 offen offset:1280 sc1
    v_fma_f32 v160, -v32, v65, v160
    v_fma_f32 v161, -v33, v65, v161
    v_mfma_f32_32x32x16_bf16 v[176:191], v[200:203], v[116:119], v[176:191]
    ds_read_b64_tr_b16 v[204:205], v245 offset:30720
    ds_read_b64_tr_b16 v[206:207], v245 offset:31232
    v_fma_f32 v162, -v34, v65, v162
    v_fma_f32 v163, -v35, v65, v163
    v_fma_f32 v164, -v36, v65, v164
    v_fma_f32 v165, -v37, v65, v165
    v_fma_f32 v166, -v38, v65, v166
    v_fma_f32 v167, -v39, v65, v167
    s_waitcnt lgkmcnt(6)
    v_mfma_f32_32x32x16_bf16 v[176:191], v[212:215], v[120:123], v[176:191]
    ds_read_b64_tr_b16 v[208:209], v245 offset:31744
    ds_read_b64_tr_b16 v[210:211], v245 offset:32256
    v_fma_f32 v168, -v40, v65, v168
    v_fma_f32 v169, -v41, v65, v169
    v_fma_f32 v170, -v42, v65, v170
    v_fma_f32 v171, -v43, v65, v171
    v_fma_f32 v172, -v44, v65, v172
    v_fma_f32 v173, -v45, v65, v173
    v_mfma_f32_32x32x16_bf16 v[176:191], v[224:227], v[124:127], v[176:191]
    v_fma_f32 v174, -v46, v65, v174
    v_fma_f32 v175, -v47, v65, v175
    v_mul_f32 v160, v48, v160
    v_mul_f32 v161, v49, v161
    v_mul_f32 v162, v50, v162
    v_mul_f32 v163, v51, v163
    s_waitcnt lgkmcnt(4)
    v_mfma_f32_32x32x16_bf16 v[176:191], v[192:195], v[128:131], v[176:191]
    v_mul_f32 v164, v52, v164
    v_mul_f32 v165, v53, v165
    v_mul_f32 v166, v54, v166
    v_mul_f32 v167, v55, v167
    v_mul_f32 v168, v56, v168
    v_mul_f32 v169, v57, v169
    v_mfma_f32_32x32x16_bf16 v[176:191], v[196:199], v[132:135], v[176:191]
    v_mul_f32 v170, v58, v170
    v_mul_f32 v171, v59, v171
    v_mul_f32 v172, v60, v172
    v_mul_f32 v173, v61, v173
    v_mul_f32 v174, v62, v174
    v_mul_f32 v175, v63, v175
    s_waitcnt lgkmcnt(0)
    v_mfma_f32_32x32x16_bf16 v[176:191], v[204:207], v[136:139], v[176:191]
    v_cvt_pk_bf16_f32 v24, v160, v161
    v_cvt_pk_bf16_f32 v25, v162, v163
    v_cvt_pk_bf16_f32 v26, v164, v165
    v_cvt_pk_bf16_f32 v27, v166, v167
    v_cvt_pk_bf16_f32 v28, v168, v169
    v_cvt_pk_bf16_f32 v29, v170, v171
    v_mfma_f32_32x32x16_bf16 v[176:191], v[208:211], v[140:143], v[176:191]
    v_cvt_pk_bf16_f32 v30, v172, v173
    v_cvt_pk_bf16_f32 v31, v174, v175
    buffer_store_dwordx4 v[24:27], v254, s[4:7], s55 offen offset:1024 sc1
    buffer_store_dwordx4 v[28:31], v254, s[4:7], s55 offen offset:1280 sc1
    s_cmp_eq_u32 s3, 0
    s_cbranch_scc1 L_wt_33
    buffer_store_dwordx4 v[16:19], v7, s[4:7], s52 offen offset:1024
    buffer_store_dwordx4 v[20:23], v7, s[4:7], s52 offen offset:1280
    buffer_store_dwordx4 v[24:27], v7, s[4:7], s50 offen offset:1024
    buffer_store_dwordx4 v[28:31], v7, s[4:7], s50 offen offset:1280
L_wtd_34:
    s_barrier
    s_nop 5
    v_pk_fma_f32 v[176:177], v[246:247], v[228:229], v[176:177] op_sel_hi:[0,1,1] neg_lo:[1,0,0] neg_hi:[1,0,0]
    v_pk_fma_f32 v[178:179], v[246:247], v[230:231], v[178:179] op_sel_hi:[0,1,1] neg_lo:[1,0,0] neg_hi:[1,0,0]
    v_pk_fma_f32 v[180:181], v[246:247], v[232:233], v[180:181] op_sel_hi:[0,1,1] neg_lo:[1,0,0] neg_hi:[1,0,0]
    v_pk_fma_f32 v[182:183], v[246:247], v[234:235], v[182:183] op_sel_hi:[0,1,1] neg_lo:[1,0,0] neg_hi:[1,0,0]
    v_pk_fma_f32 v[184:185], v[246:247], v[236:237], v[184:185] op_sel_hi:[0,1,1] neg_lo:[1,0,0] neg_hi:[1,0,0]
    v_pk_fma_f32 v[186:187], v[246:247], v[238:239], v[186:187] op_sel_hi:[0,1,1] neg_lo:[1,0,0] neg_hi:[1,0,0]
    v_pk_fma_f32 v[188:189], v[246:247], v[240:241], v[188:189] op_sel_hi:[0,1,1] neg_lo:[1,0,0] neg_hi:[1,0,0]
    v_pk_fma_f32 v[190:191], v[246:247], v[242:243], v[190:191] op_sel_hi:[0,1,1] neg_lo:[1,0,0] neg_hi:[1,0,0]
    v_pk_mul_f32 v[176:177], v[176:177], v[250:251] op_sel_hi:[1,0]
    v_pk_mul_f32 v[178:179], v[178:179], v[250:251] op_sel_hi:[1,0]
    v_pk_mul_f32 v[180:181], v[180:181], v[250:251] op_sel_hi:[1,0]
    v_pk_mul_f32 v[182:183], v[182:183], v[250:251] op_sel_hi:[1,0]
    v_pk_mul_f32 v[184:185], v[184:185], v[250:251] op_sel_hi:[1,0]
    v_pk_mul_f32 v[186:187], v[186:187], v[250:251] op_sel_hi:[1,0]
    v_pk_mul_f32 v[188:189], v[188:189], v[250:251] op_sel_hi:[1,0]
    v_pk_mul_f32 v[190:191], v[190:191], v[250:251] op_sel_hi:[1,0]
    v_cvt_pk_bf16_f32 v48, v176, v177
    v_cvt_pk_bf16_f32 v49, v178, v179
    v_cvt_pk_bf16_f32 v50, v180, v181
    v_cvt_pk_bf16_f32 v51, v182, v183
    v_cvt_pk_bf16_f32 v52, v184, v185
    v_cvt_pk_bf16_f32 v53, v186, v187
    v_cvt_pk_bf16_f32 v54, v188, v189
    v_cvt_pk_bf16_f32 v55, v190, v191
    s_cmp_eq_u32 s3, 0
    s_cbranch_scc1 L_wt_35
    buffer_store_dwordx4 v[48:51], v1, s[4:7], s53 offen offset:0
    buffer_store_dwordx4 v[52:55], v1, s[4:7], s53 offen offset:1024
L_wtd_36:
    v_mov_b32 v228, v2
    v_mov_b32 v229, v3
    v_mov_b32 v230, v2
    v_mov_b32 v231, v3
    s_waitcnt vmcnt(0)
    s_mov_b64 exec, 1
    s_cmp_eq_u32 s3, 0
    s_cbranch_scc1 L_wt_37
    buffer_store_dwordx2 v[2:3], off, s[4:7], s56
L_wtd_38:
    s_mov_b64 exec, -1
    buffer_store_dwordx4 v[228:231], v1, s[4:7], s57 offen sc1
    s_branch L_qkv_done_15
L_qkv_k_16:
    ds_read_b64_tr_b16 v[200:201], v245 offset:0
    ds_read_b64_tr_b16 v[202:203], v245 offset:512
    ds_read_b64_tr_b16 v[192:193], v244 offset:0
    ds_read_b64_tr_b16 v[194:195], v244 offset:1024
    ds_read_b64_tr_b16 v[196:197], v247 offset:0
    ds_read_b64_tr_b16 v[198:199], v247 offset:1024
    ds_read_b64_tr_b16 v[212:213], v245 offset:1024
    ds_read_b64_tr_b16 v[214:215], v245 offset:1536
    ds_read_b64_tr_b16 v[204:205], v244 offset:2048
    ds_read_b64_tr_b16 v[206:207], v244 offset:3072
    ds_read_b64_tr_b16 v[208:209], v247 offset:2048
    ds_read_b64_tr_b16 v[210:211], v247 offset:3072
    s_waitcnt vmcnt(9) lgkmcnt(6)
    v_mfma_f32_32x32x16_bf16 v[176:191], v[200:203], v[16:19], 0
    ds_read_b64_tr_b16 v[224:225], v245 offset:2048
    ds_read_b64_tr_b16 v[226:227], v245 offset:2560
    buffer_load_dwordx4 v[56:59], v1, s[4:7], s58 offen offset:2048 sc1
    v_mfma_f32_32x32x16_bf16 v[144:159], v[192:195], v[16:19], 0
    ds_read_b64_tr_b16 v[216:217], v244 offset:4096
    ds_read_b64_tr_b16 v[218:219], v244 offset:5120
    v_mfma_f32_32x32x16_bf16 v[160:175], v[196:199], v[16:19], 0
    ds_read_b64_tr_b16 v[220:221], v247 offset:4096
    ds_read_b64_tr_b16 v[222:223], v247 offset:5120
    s_waitcnt vmcnt(9) lgkmcnt(6)
    v_mfma_f32_32x32x16_bf16 v[176:191], v[212:215], v[20:23], v[176:191]
    ds_read_b64_tr_b16 v[200:201], v245 offset:3072
    ds_read_b64_tr_b16 v[202:203], v245 offset:3584
    buffer_load_dwordx4 v[60:63], v1, s[4:7], s58 offen offset:3072 sc1
    v_mfma_f32_32x32x16_bf16 v[144:159], v[204:207], v[20:23], v[144:159]
    ds_read_b64_tr_b16 v[192:193], v244 offset:6144
    ds_read_b64_tr_b16 v[194:195], v244 offset:7168
    v_mfma_f32_32x32x16_bf16 v[160:175], v[208:211], v[20:23], v[160:175]
    ds_read_b64_tr_b16 v[196:197], v247 offset:6144
    ds_read_b64_tr_b16 v[198:199], v247 offset:7168
    s_waitcnt vmcnt(9) lgkmcnt(6)
    v_mfma_f32_32x32x16_bf16 v[176:191], v[224:227], v[24:27], v[176:191]
    ds_read_b64_tr_b16 v[212:213], v245 offset:4096
    ds_read_b64_tr_b16 v[214:215], v245 offset:4608
    s_add_u32 s58, s51, 12288
    buffer_load_dwordx4 v[64:67], v1, s[4:7], s58 offen offset:0 sc1
    v_mfma_f32_32x32x16_bf16 v[144:159], v[216:219], v[24:27], v[144:159]
    ds_read_b64_tr_b16 v[204:205], v244 offset:8192
    ds_read_b64_tr_b16 v[206:207], v244 offset:9216
    v_mfma_f32_32x32x16_bf16 v[160:175], v[220:223], v[24:27], v[160:175]
    ds_read_b64_tr_b16 v[208:209], v247 offset:8192
    ds_read_b64_tr_b16 v[210:211], v247 offset:9216
    s_waitcnt vmcnt(9) lgkmcnt(6)
    v_mfma_f32_32x32x16_bf16 v[176:191], v[200:203], v[28:31], v[176:191]
    ds_read_b64_tr_b16 v[224:225], v245 offset:5120
    ds_read_b64_tr_b16 v[226:227], v245 offset:5632
    buffer_load_dwordx4 v[68:71], v1, s[4:7], s58 offen offset:1024 sc1
    v_mfma_f32_32x32x16_bf16 v[144:159], v[192:195], v[28:31], v[144:159]
    ds_read_b64_tr_b16 v[216:217], v244 offset:10240
    ds_read_b64_tr_b16 v[218:219], v244 offset:11264
    buffer_load_dwordx4 v[228:231], v1, s[4:7], s52 offen offset:0 sc1
    v_mfma_f32_32x32x16_bf16 v[160:175], v[196:199], v[28:31], v[160:175]
    ds_read_b64_tr_b16 v[220:221], v247 offset:10240
    ds_read_b64_tr_b16 v[222:223], v247 offset:11264
    s_waitcnt vmcnt(10) lgkmcnt(6)
    v_mfma_f32_32x32x16_bf16 v[176:191], v[212:215], v[32:35], v[176:191]
    ds_read_b64_tr_b16 v[200:201], v245 offset:6144
    ds_read_b64_tr_b16 v[202:203], v245 offset:6656
    buffer_load_dwordx4 v[72:75], v1, s[4:7], s58 offen offset:2048 sc1
    v_mfma_f32_32x32x16_bf16 v[144:159], v[204:207], v[32:35], v[144:159]
    ds_read_b64_tr_b16 v[192:193], v244 offset:12288
    ds_read_b64_tr_b16 v[194:195], v244 offset:13312
    v_mfma_f32_32x32x16_bf16 v[160:175], v[208:211], v[32:35], v[160:175]
    ds_read_b64_tr_b16 v[196:197], v247 offset:12288
    ds_read_b64_tr_b16 v[198:199], v247 offset:13312
    s_waitcnt vmcnt(10) lgkmcnt(6)
    v_mfma_f32_32x32x16_bf16 v[176:191], v[224:227], v[36:39], v[176:191]
    ds_read_b64_tr_b16 v[212:213], v245 offset:7168
    ds_read_b64_tr_b16 v[214:215], v245 offset:7680
    buffer_load_dwordx4 v[76:79], v1, s[4:7], s58 offen offset:3072 sc1
    v_mfma_f32_32x32x16_bf16 v[144:159], v[216:219], v[36:39], v[144:159]
    ds_read_b64_tr_b16 v[204:205], v244 offset:14336
    ds_read_b64_tr_b16 v[206:207], v244 offset:15360
    buffer_load_dwordx4 v[232:235], v1, s[4:7], s52 offen offset:1024 sc1
    v_mfma_f32_32x32x16_bf16 v[160:175], v[220:223], v[36:39], v[160:175]
    ds_read_b64_tr_b16 v[208:209], v247 offset:14336
    ds_read_b64_tr_b16 v[210:211], v247 offset:15360
    s_waitcnt vmcnt(11) lgkmcnt(6)
    v_mfma_f32_32x32x16_bf16 v[176:191], v[200:203], v[40:43], v[176:191]
    ds_read_b64_tr_b16 v[224:225], v245 offset:8192
    ds_read_b64_tr_b16 v[226:227], v245 offset:8704
    s_add_u32 s58, s51, 16384
    buffer_load_dwordx4 v[80:83], v1, s[4:7], s58 offen offset:0 sc1
    v_mfma_f32_32x32x16_bf16 v[144:159], v[192:195], v[40:43], v[144:159]
    ds_read_b64_tr_b16 v[216:217], v244 offset:16384
    ds_read_b64_tr_b16 v[218:219], v244 offset:17408
    v_mfma_f32_32x32x16_bf16 v[160:175], v[196:199], v[40:43], v[160:175]
    ds_read_b64_tr_b16 v[220:221], v247 offset:16384
    ds_read_b64_tr_b16 v[222:223], v247 offset:17408
    s_waitcnt vmcnt(11) lgkmcnt(6)
    v_mfma_f32_32x32x16_bf16 v[176:191], v[212:215], v[44:47], v[176:191]
    ds_read_b64_tr_b16 v[200:201], v245 offset:9216
    ds_read_b64_tr_b16 v[202:203], v245 offset:9728
    buffer_load_dwordx4 v[84:87], v1, s[4:7], s58 offen offset:1024 sc1
    v_mfma_f32_32x32x16_bf16 v[144:159], v[204:207], v[44:47], v[144:159]
    ds_read_b64_tr_b16 v[192:193], v244 offset:18432
    ds_read_b64_tr_b16 v[194:195], v244 offset:19456
    buffer_load_dwordx4 v[236:239], v1, s[4:7], s52 offen offset:2048 sc1
    v_mfma_f32_32x32x16_bf16 v[160:175], v[208:211], v[44:47], v[160:175]
    ds_read_b64_tr_b16 v[196:197], v247 offset:18432
    ds_read_b64_tr_b16 v[198:199], v247 offset:19456
    s_waitcnt vmcnt(12) lgkmcnt(6)
    v_mfma_f32_32x32x16_bf16 v[176:191], v[224:227], v[48:51], v[176:191]
    ds_read_b64_tr_b16 v[212:213], v245 offset:10240
    ds_read_b64_tr_b16 v[214:215], v245 offset:10752
    buffer_load_dwordx4 v[88:91], v1, s[4:7], s58 offen offset:2048 sc1
    v_mfma_f32_32x32x16_bf16 v[144:159], v[216:219], v[48:51], v[144:159]
    ds_read_b64_tr_b16 v[204:205], v244 offset:20480
    ds_read_b64_tr_b16 v[206:207], v244 offset:21504
    v_mfma_f32_32x32x16_bf16 v[160:175], v[220:223], v[48:51], v[160:175]
    ds_read_b64_tr_b16 v[208:209], v247 offset:20480
    ds_read_b64_tr_b16 v[210:211], v247 offset:21504
    s_waitcnt vmcnt(12) lgkmcnt(6)
    v_mfma_f32_32x32x16_bf16 v[176:191], v[200:203], v[52:55], v[176:191]
    ds_read_b64_tr_b16 v[224:225], v245 offset:11264
    ds_read_b64_tr_b16 v[226:227], v245 offset:11776
    buffer_load_dwordx4 v[92:95], v1, s[4:7], s58 offen offset:3072 sc1
    v_mfma_f32_32x32x16_bf16 v[144:159], v[192:195], v[52:55], v[144:159]
    ds_read_b64_tr_b16 v[216:217], v244 offset:22528
    ds_read_b64_tr_b16 v[218:219], v244 offset:23552
    buffer_load_dwordx4 v[240:243], v1, s[4:7], s52 offen offset:3072 sc1
    v_mfma_f32_32x32x16_bf16 v[160:175], v[196:199], v[52:55], v[160:175]
    ds_read_b64_tr_b16 v[220:221], v247 offset:22528
    ds_read_b64_tr_b16 v[222:223], v247 offset:23552
    s_waitcnt vmcnt(13) lgkmcnt(6)
    v_mfma_f32_32x32x16_bf16 v[176:191], v[212:215], v[56:59], v[176:191]
    ds_read_b64_tr_b16 v[200:201], v245 offset:12288
    ds_read_b64_tr_b16 v[202:203], v245 offset:12800
    s_add_u32 s58, s51, 20480
    buffer_load_dwordx4 v[96:99], v1, s[4:7], s58 offen offset:0 sc1
    s_lshr_b32 s50, s42, 1
    s_mov_b32 s54, 0x200000
    v_mfma_f32_32x32x16_bf16 v[144:159], v[204:207], v[56:59], v[144:159]
    ds_read_b64_tr_b16 v[192:193], v244 offset:24576
    ds_read_b64_tr_b16 v[194:195], v244 offset:25600
    s_mul_i32 s59, s36, 4194304
    s_add_u32 s54, s54, s59
    v_mfma_f32_32x32x16_bf16 v[160:175], v[208:211], v[56:59], v[160:175]
    ds_read_b64_tr_b16 v[196:197], v247 offset:24576
    ds_read_b64_tr_b16 v[198:199], v247 offset:25600
    s_mul_i32 s59, s50, 524288
    s_add_u32 s54, s54, s59
    s_waitcnt vmcnt(13) lgkmcnt(6)
    v_mfma_f32_32x32x16_bf16 v[176:191], v[224:227], v[60:63], v[176:191]
    ds_read_b64_tr_b16 v[212:213], v245 offset:13312
    ds_read_b64_tr_b16 v[214:215], v245 offset:13824
    buffer_load_dwordx4 v[100:103], v1, s[4:7], s58 offen offset:1024 sc1
    s_mul_i32 s59, s39, 16384
    s_add_u32 s54, s54, s59
    v_mfma_f32_32x32x16_bf16 v[144:159], v[216:219], v[60:63], v[144:159]
    ds_read_b64_tr_b16 v[204:205], v244 offset:26624
    ds_read_b64_tr_b16 v[206:207], v244 offset:27648
    s_mul_i32 s59, s41, 2048
    s_add_u32 s54, s54, s59
    v_mfma_f32_32x32x16_bf16 v[160:175], v[220:223], v[60:63], v[160:175]
    ds_read_b64_tr_b16 v[208:209], v247 offset:26624
    ds_read_b64_tr_b16 v[210:211], v247 offset:27648
    s_add_u32 s52, s37, 0x98000
    s_mul_i32 s59, s50, 8192
    s_waitcnt vmcnt(13) lgkmcnt(6)
    v_mfma_f32_32x32x16_bf16 v[176:191], v[200:203], v[64:67], v[176:191]
    ds_read_b64_tr_b16 v[224:225], v245 offset:14336
    ds_read_b64_tr_b16 v[226:227], v245 offset:14848
    buffer_load_dwordx4 v[104:107], v1, s[4:7], s58 offen offset:2048 sc1
    s_add_u32 s52, s52, s59
    s_mul_i32 s59, s41, 99328
    v_mfma_f32_32x32x16_bf16 v[144:159], v[192:195], v[64:67], v[144:159]
    ds_read_b64_tr_b16 v[216:217], v244 offset:28672
    ds_read_b64_tr_b16 v[218:219], v244 offset:29696
    s_add_u32 s52, s52, s59
    s_add_u32 s56, s38, 1024
    v_mfma_f32_32x32x16_bf16 v[160:175], v[196:199], v[64:67], v[160:175]
    ds_read_b64_tr_b16 v[220:221], v247 offset:28672
    ds_read_b64_tr_b16 v[222:223], v247 offset:29696
    s_mul_i32 s59, s42, 64
    s_add_u32 s56, s56, s59
    s_waitcnt vmcnt(13) lgkmcnt(6)
    v_mfma_f32_32x32x16_bf16 v[176:191], v[212:215], v[68:71], v[176:191]
    ds_read_b64_tr_b16 v[200:201], v245 offset:15360
    ds_read_b64_tr_b16 v[202:203], v245 offset:15872
    buffer_load_dwordx4 v[108:111], v1, s[4:7], s58 offen offset:3072 sc1
    s_mul_i32 s59, s41, 8
    s_add_u32 s56, s56, s59
    v_mfma_f32_32x32x16_bf16 v[144:159], v[204:207], v[68:71], v[144:159]
    ds_read_b64_tr_b16 v[192:193], v244 offset:30720
    ds_read_b64_tr_b16 v[194:195], v244 offset:31744
    s_mov_b32 s57, 0xa00000
    s_mul_i32 s59, s36, 1048576
    v_mfma_f32_32x32x16_bf16 v[160:175], v[208:211], v[68:71], v[160:175]
    ds_read_b64_tr_b16 v[196:197], v247 offset:30720
    ds_read_b64_tr_b16 v[198:199], v247 offset:31744
    s_add_u32 s57, s57, s59
    s_mul_i32 s59, s42, 65536
    s_waitcnt vmcnt(12) lgkmcnt(6)
    v_mfma_f32_32x32x16_bf16 v[176:191], v[224:227], v[72:75], v[176:191]
    s_add_u32 s58, s51, 24576
    buffer_load_dwordx4 v[112:115], v1, s[4:7], s58 offen offset:0 sc1
    s_add_u32 s57, s57, s59
    s_mul_i32 s59, s39, 8192
    v_mfma_f32_32x32x16_bf16 v[144:159], v[216:219], v[72:75], v[144:159]
    ds_read_b64_tr_b16 v[204:205], v244 offset:32768
    ds_read_b64_tr_b16 v[206:207], v244 offset:33792
    s_add_u32 s57, s57, s59
    s_mul_i32 s59, s41, 1024
    v_mfma_f32_32x32x16_bf16 v[160:175], v[220:223], v[72:75], v[160:175]
    ds_read_b64_tr_b16 v[208:209], v247 offset:32768
    ds_read_b64_tr_b16 v[210:211], v247 offset:33792
    s_add_u32 s57, s57, s59
    s_add_u32 s53, s37, 0x90000
    s_waitcnt vmcnt(12) lgkmcnt(4)
    v_mfma_f32_32x32x16_bf16 v[176:191], v[200:203], v[76:79], v[176:191]
    buffer_load_dwordx4 v[116:119], v1, s[4:7], s58 offen offset:1024 sc1
    s_mul_i32 s59, s42, 2048
    s_add_u32 s53, s53, s59
    v_mfma_f32_32x32x16_bf16 v[144:159], v[192:195], v[76:79], v[144:159]
    ds_read_b64_tr_b16 v[216:217], v244 offset:34816
    ds_read_b64_tr_b16 v[218:219], v244 offset:35840
    s_mul_i32 s59, s41, 99328
    s_add_u32 s53, s53, s59
    v_mfma_f32_32x32x16_bf16 v[160:175], v[196:199], v[76:79], v[160:175]
    ds_read_b64_tr_b16 v[220:221], v247 offset:34816
    ds_read_b64_tr_b16 v[222:223], v247 offset:35840
    s_barrier
    s_waitcnt vmcnt(11) lgkmcnt(4)
    v_mfma_f32_32x32x16_bf16 v[144:159], v[204:207], v[80:83], v[144:159]
    ds_read_b64_tr_b16 v[192:193], v244 offset:36864
    ds_read_b64_tr_b16 v[194:195], v244 offset:37888
    buffer_load_dwordx4 v[120:123], v1, s[4:7], s58 offen offset:2048 sc1
    v_mfma_f32_32x32x16_bf16 v[160:175], v[208:211], v[80:83], v[160:175]
    ds_read_b64_tr_b16 v[196:197], v247 offset:36864
    ds_read_b64_tr_b16 v[198:199], v247 offset:37888
    s_waitcnt vmcnt(11) lgkmcnt(4)
    v_mfma_f32_32x32x16_bf16 v[144:159], v[216:219], v[84:87], v[144:159]
    ds_read_b64_tr_b16 v[204:205], v244 offset:38912
    ds_read_b64_tr_b16 v[206:207], v244 offset:39936
    buffer_load_dwordx4 v[124:127], v1, s[4:7], s58 offen offset:3072 sc1
    v_mfma_f32_32x32x16_bf16 v[160:175], v[220:223], v[84:87], v[160:175]
    ds_read_b64_tr_b16 v[208:209], v247 offset:38912
    ds_read_b64_tr_b16 v[210:211], v247 offset:39936
    s_waitcnt vmcnt(8) lgkmcnt(4)
    v_mfma_f32_32x32x16_bf16 v[144:159], v[192:195], v[88:91], v[144:159]
    ds_read_b64_tr_b16 v[216:217], v244 offset:40960
    ds_read_b64_tr_b16 v[218:219], v244 offset:41984
    s_add_u32 s58, s51, 28672
    buffer_load_dwordx4 v[128:131], v1, s[4:7], s58 offen offset:0 sc1
    v_add_f32 v228, v228, v229
    v_add_f32 v228, v228, v230
    v_mfma_f32_32x32x16_bf16 v[160:175], v[196:199], v[88:91], v[160:175]
    ds_read_b64_tr_b16 v[220:221], v247 offset:40960
    ds_read_b64_tr_b16 v[222:223], v247 offset:41984
    v_add_f32 v228, v228, v231
    v_add_f32 v228, v228, v232
    s_waitcnt vmcnt(9) lgkmcnt(4)
    v_mfma_f32_32x32x16_bf16 v[144:159], v[204:207], v[92:95], v[144:159]
    ds_read_b64_tr_b16 v[192:193], v244 offset:43008
    ds_read_b64_tr_b16 v[194:195], v244 offset:44032
    buffer_load_dwordx4 v[132:135], v1, s[4:7], s58 offen offset:1024 sc1
    v_add_f32 v228, v228, v233
    v_add_f32 v228, v228, v234
    v_mfma_f32_32x32x16_bf16 v[160:175], v[208:211], v[92:95], v[160:175]
    ds_read_b64_tr_b16 v[196:197], v247 offset:43008
    ds_read_b64_tr_b16 v[198:199], v247 offset:44032
    v_add_f32 v228, v228, v235
    v_add_f32 v228, v228, v236
    s_waitcnt vmcnt(9) lgkmcnt(4)
    v_mfma_f32_32x32x16_bf16 v[144:159], v[216:219], v[96:99], v[144:159]
    ds_read_b64_tr_b16 v[204:205], v244 offset:45056
    ds_read_b64_tr_b16 v[206:207], v244 offset:46080
    buffer_load_dwordx4 v[136:139], v1, s[4:7], s58 offen offset:2048 sc1
    v_add_f32 v228, v228, v237
    v_add_f32 v228, v228, v238
    v_mfma_f32_32x32x16_bf16 v[160:175], v[220:223], v[96:99], v[160:175]
    ds_read_b64_tr_b16 v[208:209], v247 offset:45056
    ds_read_b64_tr_b16 v[210:211], v247 offset:46080
    v_add_f32 v228, v228, v239
    v_add_f32 v228, v228, v240
    s_waitcnt vmcnt(9) lgkmcnt(4)
    v_mfma_f32_32x32x16_bf16 v[144:159], v[192:195], v[100:103], v[144:159]
    ds_read_b64_tr_b16 v[216:217], v244 offset:47104
    ds_read_b64_tr_b16 v[218:219], v244 offset:48128
    buffer_load_dwordx4 v[140:143], v1, s[4:7], s58 offen offset:3072 sc1
    v_add_f32 v228, v228, v241
    v_add_f32 v228, v228, v242
    v_mfma_f32_32x32x16_bf16 v[160:175], v[196:199], v[100:103], v[160:175]
    ds_read_b64_tr_b16 v[220:221], v247 offset:47104
    ds_read_b64_tr_b16 v[222:223], v247 offset:48128
    v_add_f32 v228, v228, v243
    v_mov_b32 v229, v228
    s_barrier
    s_waitcnt vmcnt(9) lgkmcnt(4)
    v_mfma_f32_32x32x16_bf16 v[144:159], v[204:207], v[104:107], v[144:159]
    ds_read_b64_tr_b16 v[192:193], v244 offset:49152
    ds_read_b64_tr_b16 v[194:195], v244 offset:50176
    s_nop 1
    v_permlane32_swap_b32 v228, v229
    v_mfma_f32_32x32x16_bf16 v[160:175], v[208:211], v[104:107], v[160:175]
    ds_read_b64_tr_b16 v[196:197], v247 offset:49152
    ds_read_b64_tr_b16 v[198:199], v247 offset:50176
    s_nop 1
    v_mul_f32 v246, 0x3b000000, v228
    s_waitcnt vmcnt(8) lgkmcnt(4)
    v_mfma_f32_32x32x16_bf16 v[144:159], v[216:219], v[108:111], v[144:159]
    ds_read_b64_tr_b16 v[204:205], v244 offset:51200
    ds_read_b64_tr_b16 v[206:207], v244 offset:52224
    v_mul_f32 v229, 0x3b000000, v229
    v_fma_f32 v229, -v246, v246, v229
    v_mfma_f32_32x32x16_bf16 v[160:175], v[220:223], v[108:111], v[160:175]
    ds_read_b64_tr_b16 v[208:209], v247 offset:51200
    ds_read_b64_tr_b16 v[210:211], v247 offset:52224
    v_max_f32 v229, 0, v229
    v_add_f32 v230, 0x3727c5ac, v229
    s_waitcnt vmcnt(7) lgkmcnt(4)
    v_mfma_f32_32x32x16_bf16 v[144:159], v[192:195], v[112:115], v[144:159]
    ds_read_b64_tr_b16 v[216:217], v244 offset:53248
    ds_read_b64_tr_b16 v[218:219], v244 offset:54272
    v_rsq_f32 v248, v230
    s_nop 0
    v_mfma_f32_32x32x16_bf16 v[160:175], v[196:199], v[112:115], v[160:175]
    ds_read_b64_tr_b16 v[220:221], v247 offset:53248
    ds_read_b64_tr_b16 v[222:223], v247 offset:54272
    v_mul_f32 v250, 0x3eb8aa3b, v248
    ds_read_b128 v[32:35], v251 offset:0
    s_waitcnt vmcnt(6) lgkmcnt(5)
    v_mfma_f32_32x32x16_bf16 v[144:159], v[204:207], v[116:119], v[144:159]
    ds_read_b64_tr_b16 v[192:193], v244 offset:55296
    ds_read_b64_tr_b16 v[194:195], v244 offset:56320
    ds_read_b128 v[36:39], v251 offset:32
    ds_read_b128 v[40:43], v251 offset:64
    v_mfma_f32_32x32x16_bf16 v[160:175], v[208:211], v[116:119], v[160:175]
    ds_read_b64_tr_b16 v[196:197], v247 offset:55296
    ds_read_b64_tr_b16 v[198:199], v247 offset:56320
    ds_read_b128 v[44:47], v251 offset:96
    ds_read_b128 v[48:51], v251 offset:128
    s_waitcnt vmcnt(5) lgkmcnt(9)
    v_mfma_f32_32x32x16_bf16 v[144:159], v[216:219], v[120:123], v[144:159]
    ds_read_b64_tr_b16 v[204:205], v244 offset:57344
    ds_read_b64_tr_b16 v[206:207], v244 offset:58368
    ds_read_b128 v[52:55], v251 offset:160
    ds_read_b128 v[56:59], v251 offset:192
    v_mfma_f32_32x32x16_bf16 v[160:175], v[220:223], v[120:123], v[160:175]
    ds_read_b64_tr_b16 v[208:209], v247 offset:57344
    ds_read_b64_tr_b16 v[210:211], v247 offset:58368
    ds_read_b128 v[60:63], v251 offset:224
    s_waitcnt vmcnt(4) lgkmcnt(9)
    v_mfma_f32_32x32x16_bf16 v[144:159], v[192:195], v[124:127], v[144:159]
    ds_read_b64_tr_b16 v[216:217], v244 offset:59392
    ds_read_b64_tr_b16 v[218:219], v244 offset:60416
    v_mfma_f32_32x32x16_bf16 v[160:175], v[196:199], v[124:127], v[160:175]
    ds_read_b64_tr_b16 v[220:221], v247 offset:59392
    ds_read_b64_tr_b16 v[222:223], v247 offset:60416
    s_waitcnt vmcnt(3) lgkmcnt(5)
    v_mfma_f32_32x32x16_bf16 v[144:159], v[204:207], v[128:131], v[144:159]
    ds_read_b64_tr_b16 v[192:193], v244 offset:61440
    ds_read_b64_tr_b16 v[194:195], v244 offset:62464
    v_mfma_f32_32x32x16_bf16 v[160:175], v[208:211], v[128:131], v[160:175]
    ds_read_b64_tr_b16 v[196:197], v247 offset:61440
    ds_read_b64_tr_b16 v[198:199], v247 offset:62464
    s_waitcnt vmcnt(2) lgkmcnt(4)
    v_mfma_f32_32x32x16_bf16 v[144:159], v[216:219], v[132:135], v[144:159]
    ds_read_b64_tr_b16 v[204:205], v244 offset:63488
    ds_read_b64_tr_b16 v[206:207], v244 offset:64512
    v_mfma_f32_32x32x16_bf16 v[160:175], v[220:223], v[132:135], v[160:175]
    ds_read_b64_tr_b16 v[208:209], v247 offset:63488
    ds_read_b64_tr_b16 v[210:211], v247 offset:64512
    s_waitcnt vmcnt(1) lgkmcnt(4)
    v_mfma_f32_32x32x16_bf16 v[144:159], v[192:195], v[136:139], v[144:159]
    ds_read_b64_tr_b16 v[200:201], v245 offset:16384
    ds_read_b64_tr_b16 v[202:203], v245 offset:16896
    v_mfma_f32_32x32x16_bf16 v[160:175], v[196:199], v[136:139], v[160:175]
    ds_read_b64_tr_b16 v[212:213], v245 offset:17408
    ds_read_b64_tr_b16 v[214:215], v245 offset:17920
    s_waitcnt vmcnt(0) lgkmcnt(4)
    v_mfma_f32_32x32x16_bf16 v[144:159], v[204:207], v[140:143], v[144:159]
    ds_read_b64_tr_b16 v[224:225], v245 offset:18432
    ds_read_b64_tr_b16 v[226:227], v245 offset:18944
    v_mfma_f32_32x32x16_bf16 v[160:175], v[208:211], v[140:143], v[160:175]
    s_waitcnt lgkmcnt(4)
    v_mfma_f32_32x32x16_bf16 v[176:191], v[200:203], v[80:83], v[176:191]
    ds_read_b64_tr_b16 v[192:193], v245 offset:19456
    ds_read_b64_tr_b16 v[194:195], v245 offset:19968
    ds_read_b64_tr_b16 v[196:197], v245 offset:20480
    ds_read_b64_tr_b16 v[198:199], v245 offset:20992
    ds_read_b128 v[228:231], v251 offset:256
    ds_read_b128 v[232:235], v251 offset:288
    ds_read_b128 v[236:239], v251 offset:320
    ds_read_b128 v[240:243], v251 offset:352
    s_add_u32 s55, s54, 0x20000
    s_waitcnt lgkmcnt(10)
    v_mfma_f32_32x32x16_bf16 v[176:191], v[212:215], v[84:87], v[176:191]
    ds_read_b64_tr_b16 v[204:205], v245 offset:21504
    ds_read_b64_tr_b16 v[206:207], v245 offset:22016
    ds_read_b64_tr_b16 v[208:209], v245 offset:22528
    ds_read_b64_tr_b16 v[210:211], v245 offset:23040
    s_add_u32 s50, s52, 4096
    s_add_u32 s58, s54, 0x40000
    s_add_u32 s51, s54, 0x60000
    v_fma_f32 v144, -v246, v32, v144
    v_fma_f32 v145, -v246, v33, v145
    v_fma_f32 v146, -v246, v34, v146
    s_waitcnt lgkmcnt(12)
    v_mfma_f32_32x32x16_bf16 v[176:191], v[224:227], v[88:91], v[176:191]
    ds_read_b64_tr_b16 v[216:217], v245 offset:23552
    ds_read_b64_tr_b16 v[218:219], v245 offset:24064
    v_fma_f32 v147, -v246, v35, v147
    v_fma_f32 v148, -v246, v36, v148
    v_fma_f32 v149, -v246, v37, v149
    v_fma_f32 v150, -v246, v38, v150
    v_fma_f32 v151, -v246, v39, v151
    v_fma_f32 v152, -v246, v40, v152
    s_waitcnt lgkmcnt(12)
    v_mfma_f32_32x32x16_bf16 v[176:191], v[192:195], v[92:95], v[176:191]
    ds_read_b64_tr_b16 v[220:221], v245 offset:24576
    ds_read_b64_tr_b16 v[222:223], v245 offset:25088
    v_fma_f32 v153, -v246, v41, v153
    v_fma_f32 v154, -v246, v42, v154
    v_fma_f32 v155, -v246, v43, v155
    v_fma_f32 v156, -v246, v44, v156
    v_fma_f32 v157, -v246, v45, v157
    v_fma_f32 v158, -v246, v46, v158
    s_waitcnt lgkmcnt(6)
    v_mfma_f32_32x32x16_bf16 v[176:191], v[196:199], v[96:99], v[176:191]
    ds_read_b64_tr_b16 v[200:201], v245 offset:25600
    ds_read_b64_tr_b16 v[202:203], v245 offset:26112
    v_fma_f32 v159, -v246, v47, v159
    v_mul_f32 v144, v248, v144
    v_mul_f32 v145, v248, v145
    v_mul_f32 v146, v248, v146
    v_mul_f32 v147, v248, v147
    v_mul_f32 v148, v248, v148
    v_mfma_f32_32x32x16_bf16 v[176:191], v[204:207], v[100:103], v[176:191]
    ds_read_b64_tr_b16 v[212:213], v245 offset:26624
    ds_read_b64_tr_b16 v[214:215], v245 offset:27136
    v_mul_f32 v149, v248, v149
    v_mul_f32 v150, v248, v150
    v_mul_f32 v151, v248, v151
    v_mul_f32 v152, v248, v152
    v_mul_f32 v153, v248, v153
    v_mul_f32 v154, v248, v154
    s_waitcnt lgkmcnt(6)
    v_mfma_f32_32x32x16_bf16 v[176:191], v[208:211], v[104:107], v[176:191]
    ds_read_b64_tr_b16 v[224:225], v245 offset:27648
    ds_read_b64_tr_b16 v[226:227], v245 offset:28160
    v_mul_f32 v155, v248, v155
    v_mul_f32 v156, v248, v156
    v_mul_f32 v157, v248, v157
    v_mul_f32 v158, v248, v158
    v_mul_f32 v159, v248, v159
    v_cvt_pk_bf16_f32 v16, v144, v145
    v_mfma_f32_32x32x16_bf16 v[176:191], v[216:219], v[108:111], v[176:191]
    ds_read_b64_tr_b16 v[192:193], v245 offset:28672
    ds_read_b64_tr_b16 v[194:195], v245 offset:29184
    v_cvt_pk_bf16_f32 v17, v146, v147
    v_cvt_pk_bf16_f32 v18, v148, v149
    v_cvt_pk_bf16_f32 v19, v150, v151
    v_cvt_pk_bf16_f32 v20, v152, v153
    v_cvt_pk_bf16_f32 v21, v154, v155
    v_cvt_pk_bf16_f32 v22, v156, v157
    s_waitcnt lgkmcnt(6)
    v_mfma_f32_32x32x16_bf16 v[176:191], v[220:223], v[112:115], v[176:191]
    ds_read_b64_tr_b16 v[196:197], v245 offset:29696
    ds_read_b64_tr_b16 v[198:199], v245 offset:30208
    v_cvt_pk_bf16_f32 v23, v158, v159
    buffer_store_dwordx4 v[16:19], v253, s[4:7], s54 offen sc1
    buffer_store_dwordx4 v[20:23], v253, s[4:7], s55 offen sc1
    v_fma_f32 v160, -v246, v48, v160
    v_fma_f32 v161, -v246, v49, v161
    v_fma_f32 v162, -v246, v50, v162
    v_mfma_f32_32x32x16_bf16 v[176:191], v[200:203], v[116:119], v[176:191]
    ds_read_b64_tr_b16 v[204:205], v245 offset:30720
    ds_read_b64_tr_b16 v[206:207], v245 offset:31232
    v_fma_f32 v163, -v246, v51, v163
    v_fma_f32 v164, -v246, v52, v164
    v_fma_f32 v165, -v246, v53, v165
    v_fma_f32 v166, -v246, v54, v166
    v_fma_f32 v167, -v246, v55, v167
    v_fma_f32 v168, -v246, v56, v168
    s_waitcnt lgkmcnt(6)
    v_mfma_f32_32x32x16_bf16 v[176:191], v[212:215], v[120:123], v[176:191]
    ds_read_b64_tr_b16 v[208:209], v245 offset:31744
    ds_read_b64_tr_b16 v[210:211], v245 offset:32256
    v_fma_f32 v169, -v246, v57, v169
    v_fma_f32 v170, -v246, v58, v170
    v_fma_f32 v171, -v246, v59, v171
    v_fma_f32 v172, -v246, v60, v172
    v_fma_f32 v173, -v246, v61, v173
    v_fma_f32 v174, -v246, v62, v174
    v_mfma_f32_32x32x16_bf16 v[176:191], v[224:227], v[124:127], v[176:191]
    v_fma_f32 v175, -v246, v63, v175
    v_mul_f32 v160, v248, v160
    v_mul_f32 v161, v248, v161
    v_mul_f32 v162, v248, v162
    v_mul_f32 v163, v248, v163
    v_mul_f32 v164, v248, v164
    s_waitcnt lgkmcnt(4)
    v_mfma_f32_32x32x16_bf16 v[176:191], v[192:195], v[128:131], v[176:191]
    v_mul_f32 v165, v248, v165
    v_mul_f32 v166, v248, v166
    v_mul_f32 v167, v248, v167
    v_mul_f32 v168, v248, v168
    v_mul_f32 v169, v248, v169
    v_mul_f32 v170, v248, v170
    v_mfma_f32_32x32x16_bf16 v[176:191], v[196:199], v[132:135], v[176:191]
    v_mul_f32 v171, v248, v171
    v_mul_f32 v172, v248, v172
    v_mul_f32 v173, v248, v173
    v_mul_f32 v174, v248, v174
    v_mul_f32 v175, v248, v175
    v_cvt_pk_bf16_f32 v24, v160, v161
    s_waitcnt lgkmcnt(0)
    v_mfma_f32_32x32x16_bf16 v[176:191], v[204:207], v[136:139], v[176:191]
    v_cvt_pk_bf16_f32 v25, v162, v163
    v_cvt_pk_bf16_f32 v26, v164, v165
    v_cvt_pk_bf16_f32 v27, v166, v167
    v_cvt_pk_bf16_f32 v28, v168, v169
    v_cvt_pk_bf16_f32 v29, v170, v171
    v_cvt_pk_bf16_f32 v30, v172, v173
    v_mfma_f32_32x32x16_bf16 v[176:191], v[208:211], v[140:143], v[176:191]
    v_cvt_pk_bf16_f32 v31, v174, v175
    buffer_store_dwordx4 v[24:27], v253, s[4:7], s58 offen sc1
    buffer_store_dwordx4 v[28:31], v253, s[4:7], s51 offen sc1
    s_cmp_eq_u32 s3, 0
    s_cbranch_scc1 L_wt_39
    buffer_store_dwordx4 v[16:19], v253, s[4:7], s52 offen offset:0
    buffer_store_dwordx4 v[20:23], v253, s[4:7], s52 offen offset:2048
    buffer_store_dwordx4 v[24:27], v253, s[4:7], s50 offen offset:0
    buffer_store_dwordx4 v[28:31], v253, s[4:7], s50 offen offset:2048
L_wtd_40:
    s_barrier
    s_nop 6
    v_pk_fma_f32 v[176:177], v[246:247], v[228:229], v[176:177] op_sel_hi:[0,1,1] neg_lo:[1,0,0] neg_hi:[1,0,0]
    v_pk_fma_f32 v[178:179], v[246:247], v[230:231], v[178:179] op_sel_hi:[0,1,1] neg_lo:[1,0,0] neg_hi:[1,0,0]
    v_pk_fma_f32 v[180:181], v[246:247], v[232:233], v[180:181] op_sel_hi:[0,1,1] neg_lo:[1,0,0] neg_hi:[1,0,0]
    v_pk_fma_f32 v[182:183], v[246:247], v[234:235], v[182:183] op_sel_hi:[0,1,1] neg_lo:[1,0,0] neg_hi:[1,0,0]
    v_pk_fma_f32 v[184:185], v[246:247], v[236:237], v[184:185] op_sel_hi:[0,1,1] neg_lo:[1,0,0] neg_hi:[1,0,0]
    v_pk_fma_f32 v[186:187], v[246:247], v[238:239], v[186:187] op_sel_hi:[0,1,1] neg_lo:[1,0,0] neg_hi:[1,0,0]
    v_pk_fma_f32 v[188:189], v[246:247], v[240:241], v[188:189] op_sel_hi:[0,1,1] neg_lo:[1,0,0] neg_hi:[1,0,0]
    v_pk_fma_f32 v[190:191], v[246:247], v[242:243], v[190:191] op_sel_hi:[0,1,1] neg_lo:[1,0,0] neg_hi:[1,0,0]
    v_pk_mul_f32 v[176:177], v[176:177], v[250:251] op_sel_hi:[1,0]
    v_pk_mul_f32 v[178:179], v[178:179], v[250:251] op_sel_hi:[1,0]
    v_pk_mul_f32 v[180:181], v[180:181], v[250:251] op_sel_hi:[1,0]
    v_pk_mul_f32 v[182:183], v[182:183], v[250:251] op_sel_hi:[1,0]
    v_pk_mul_f32 v[184:185], v[184:185], v[250:251] op_sel_hi:[1,0]
    v_pk_mul_f32 v[186:187], v[186:187], v[250:251] op_sel_hi:[1,0]
    v_pk_mul_f32 v[188:189], v[188:189], v[250:251] op_sel_hi:[1,0]
    v_pk_mul_f32 v[190:191], v[190:191], v[250:251] op_sel_hi:[1,0]
    v_cvt_pk_bf16_f32 v48, v176, v177
    v_cvt_pk_bf16_f32 v49, v178, v179
    v_cvt_pk_bf16_f32 v50, v180, v181
    v_cvt_pk_bf16_f32 v51, v182, v183
    v_cvt_pk_bf16_f32 v52, v184, v185
    v_cvt_pk_bf16_f32 v53, v186, v187
    v_cvt_pk_bf16_f32 v54, v188, v189
    v_cvt_pk_bf16_f32 v55, v190, v191
    s_cmp_eq_u32 s3, 0
    s_cbranch_scc1 L_wt_41
    buffer_store_dwordx4 v[48:51], v1, s[4:7], s53 offen offset:0
    buffer_store_dwordx4 v[52:55], v1, s[4:7], s53 offen offset:1024
L_wtd_42:
    v_mov_b32 v228, v2
    v_mov_b32 v229, v3
    v_mov_b32 v230, v2
    v_mov_b32 v231, v3
    s_waitcnt vmcnt(0)
    s_mov_b64 exec, 1
    s_cmp_eq_u32 s3, 0
    s_cbranch_scc1 L_wt_43
    buffer_store_dwordx2 v[2:3], off, s[4:7], s56
L_wtd_44:
    s_mov_b64 exec, -1
    buffer_store_dwordx4 v[228:231], v1, s[4:7], s57 offen sc1
    s_branch L_qkv_done_15
L_qkv_h_14:
    s_cmp_lg_u32 s36, 0
    s_cbranch_scc1 L_qh1_45
    s_mov_b32 s8, s14
    s_and_b32 s9, s15, 0xffff
    s_mov_b32 s10, 0x180000
    s_mov_b32 s11, 0x20000
    v_lshrrev_b32 v44, 3, v0
    v_mul_u32_u24 v44, 3072, v44
    v_and_b32 v6, 7, v0
    v_lshrrev_b32 v7, 2, v0
    v_and_b32 v7, 4, v7
    v_xor_b32 v6, v6, v7
    v_lshl_or_b32 v44, v6, 4, v44
    v_lshrrev_b32 v40, 2, v0
    v_mul_u32_u24 v40, 3072, v40
    v_and_b32 v41, 3, v0
    v_lshl_or_b32 v40, v41, 4, v40
    s_and_b32 s50, s42, 1
    s_lshr_b32 s51, s42, 1
    s_mul_i32 s50, s50, -1024
    s_add_u32 s53, s50, 0x800
    s_mul_i32 s59, s49, 98304
    s_add_u32 s53, s53, s59
    s_mul_i32 s59, s51, 128
    s_add_u32 s53, s53, s59
    s_mov_b32 s55, 0x0
    s_mul_i32 s59, s49, 98304
    s_add_u32 s55, s55, s59
    s_mul_i32 s59, s42, 64
    s_add_u32 s55, s55, s59
    s_lshl_b32 s54, s49, 12
    s_mov_b32 s56, 0x10000
    s_mul_i32 s59, s49, 2048
    s_add_u32 s56, s56, s59
    s_mov_b32 s52, 2
L_dl_48:
    s_add_u32 m0, s54, 0
    s_nop 0
    buffer_load_dwordx4 v44, s[8:11], s53 offen lds
    s_add_u32 s53, s53, 24576
    s_add_u32 m0, s54, 1024
    s_nop 0
    buffer_load_dwordx4 v44, s[8:11], s53 offen lds
    s_add_u32 s53, s53, 24576
    s_add_u32 m0, s56, 0
    s_nop 0
    buffer_load_dwordx4 v40, s[8:11], s55 offen lds
    s_add_u32 s55, s55, 49152
    s_add_u32 m0, s54, 2048
    s_nop 0
    buffer_load_dwordx4 v44, s[8:11], s53 offen lds
    s_add_u32 s53, s53, 24576
    s_add_u32 m0, s54, 3072
    s_nop 0
    buffer_load_dwordx4 v44, s[8:11], s53 offen lds
    s_add_u32 s53, s53, 319488
    s_add_u32 m0, s56, 1024
    s_nop 0
    buffer_load_dwordx4 v40, s[8:11], s55 offen lds
    s_add_u32 s55, s55, 344064
    s_add_u32 s54, s54, 16384
    s_add_u32 s56, s56, 8192
    s_sub_u32 s52, s52, 1
    s_cmp_lg_u32 s52, 0
    s_cbranch_scc1 L_dl_48
    s_waitcnt lgkmcnt(0)
    s_add_u32 s35, s35, 16
    v_mov_b32 v2, s35
    v_not_b32 v3, v2
    v_mov_b32 v64, 0
    v_mov_b32 v65, 0
    v_mov_b32 v66, 0
    v_mov_b32 v67, 0
    v_mov_b32 v68, 0
    v_mov_b32 v69, 0
    v_mov_b32 v70, 0
    v_mov_b32 v71, 0
    v_mov_b32 v72, 0
    v_mov_b32 v73, 0
    v_mov_b32 v74, 0
    v_mov_b32 v75, 0
    v_mov_b32 v76, 0
    v_mov_b32 v77, 0
    v_mov_b32 v78, 0
    v_mov_b32 v79, 0
    v_mov_b32 v80, 0
    v_mov_b32 v81, 0
    v_mov_b32 v82, 0
    v_mov_b32 v83, 0
    v_mov_b32 v84, 0
    v_mov_b32 v85, 0
    v_mov_b32 v86, 0
    v_mov_b32 v87, 0
    v_mov_b32 v88, 0
    v_mov_b32 v89, 0
    v_mov_b32 v90, 0
    v_mov_b32 v91, 0
    v_mov_b32 v92, 0
    v_mov_b32 v93, 0
    v_mov_b32 v94, 0
    v_mov_b32 v95, 0
    v_mov_b32 v96, 0
    v_mov_b32 v97, 0
    v_mov_b32 v98, 0
    v_mov_b32 v99, 0
    v_mov_b32 v100, 0
    v_mov_b32 v101, 0
    v_mov_b32 v102, 0
    v_mov_b32 v103, 0
    v_mov_b32 v104, 0
    v_mov_b32 v105, 0
    v_mov_b32 v106, 0
    v_mov_b32 v107, 0
    v_mov_b32 v108, 0
    v_mov_b32 v109, 0
    v_mov_b32 v110, 0
    v_mov_b32 v111, 0
    v_mov_b32 v52, 0x3f803f80
    v_mov_b32 v53, 0x3f803f80
    v_mov_b32 v54, 0x3f803f80
    v_mov_b32 v55, 0x3f803f80
    v_bfe_u32 v42, v0, 2, 2
    v_lshrrev_b32 v6, 2, v255
    v_add_u32 v42, v42, v6
    v_mul_u32_u24 v42, 128, v42
    v_add_u32 v42, v42, v252
    v_bfe_u32 v6, v0, 3, 1
    v_lshl_or_b32 v42, v6, 6, v42
    s_lshl_b32 s50, s49, 12
    v_add_u32 v42, s50, v42
    v_xor_b32 v48, 64, v42
    v_bfe_u32 v50, v0, 2, 2
    v_lshrrev_b32 v6, 2, v255
    v_add_u32 v50, v50, v6
    v_mul_u32_u24 v50, 64, v50
    v_add_u32 v50, v50, v252
    s_mov_b32 s50, 0x10000
    s_mul_i32 s59, s49, 2048
    s_add_u32 s50, s50, s59
    v_add_u32 v50, s50, v50
    s_mov_b32 s61, 0
L_qhl_47:
    s_cmp_ge_u32 s61, 2
    s_cbranch_scc1 L_qw_49
    s_add_u32 m0, s54, 0
    s_nop 0
    buffer_load_dwordx4 v44, s[8:11], s53 offen lds
    s_add_u32 s53, s53, 24576
    s_add_u32 m0, s54, 1024
    s_nop 0
    buffer_load_dwordx4 v44, s[8:11], s53 offen lds
    s_add_u32 s53, s53, 24576
    s_add_u32 m0, s56, 0
    s_nop 0
    buffer_load_dwordx4 v40, s[8:11], s55 offen lds
    s_add_u32 s55, s55, 49152
    s_add_u32 m0, s54, 2048
    s_nop 0
    buffer_load_dwordx4 v44, s[8:11], s53 offen lds
    s_add_u32 s53, s53, 24576
    s_add_u32 m0, s54, 3072
    s_nop 0
    buffer_load_dwordx4 v44, s[8:11], s53 offen lds
    s_add_u32 s53, s53, 319488
    s_add_u32 m0, s56, 1024
    s_nop 0
    buffer_load_dwordx4 v40, s[8:11], s55 offen lds
    s_add_u32 s55, s55, 344064
    s_add_u32 s54, s54, 16384
    s_add_u32 s56, s56, 8192
    s_waitcnt vmcnt(12)
    s_branch L_qw_50
L_qw_49:
    s_waitcnt vmcnt(6)
    s_cmp_eq_u32 s61, 2
    s_cbranch_scc1 L_qw_50
    s_waitcnt vmcnt(0)
L_qw_50:
    ds_read_b64_tr_b16 v[16:17], v42 offset:0
    ds_read_b64_tr_b16 v[18:19], v42 offset:1024
    ds_read_b64_tr_b16 v[20:21], v48 offset:0
    ds_read_b64_tr_b16 v[22:23], v48 offset:1024
    ds_read_b64_tr_b16 v[24:25], v50 offset:0
    ds_read_b64_tr_b16 v[26:27], v50 offset:512
    ds_read_b64_tr_b16 v[28:29], v42 offset:2048
    ds_read_b64_tr_b16 v[30:31], v42 offset:3072
    ds_read_b64_tr_b16 v[32:33], v48 offset:2048
    ds_read_b64_tr_b16 v[34:35], v48 offset:3072
    ds_read_b64_tr_b16 v[36:37], v50 offset:1024
    ds_read_b64_tr_b16 v[38:39], v50 offset:1536
    s_waitcnt lgkmcnt(10)
    v_mfma_f32_32x32x16_bf16 v[64:79], v[52:55], v[16:19], v[64:79]
    s_waitcnt lgkmcnt(8)
    v_mfma_f32_32x32x16_bf16 v[80:95], v[52:55], v[20:23], v[80:95]
    s_waitcnt lgkmcnt(6)
    v_mfma_f32_32x32x16_bf16 v[96:111], v[52:55], v[24:27], v[96:111]
    s_waitcnt lgkmcnt(4)
    v_mfma_f32_32x32x16_bf16 v[64:79], v[52:55], v[28:31], v[64:79]
    s_waitcnt lgkmcnt(2)
    v_mfma_f32_32x32x16_bf16 v[80:95], v[52:55], v[32:35], v[80:95]
    s_waitcnt lgkmcnt(0)
    v_mfma_f32_32x32x16_bf16 v[96:111], v[52:55], v[36:39], v[96:111]
    v_add_u32 v42, 16384, v42
    v_add_u32 v48, 16384, v48
    v_add_u32 v50, 8192, v50
    s_add_u32 s61, s61, 1
    s_cmp_lt_u32 s61, 4
    s_cbranch_scc1 L_qhl_47
    v_and_b32 v41, 31, v0
    v_lshlrev_b32 v41, 2, v41
    s_mov_b32 s50, 0x27a00
    s_mul_i32 s59, s49, 384
    s_add_u32 s50, s50, s59
    v_add_u32 v42, s50, v41
    s_nop 7
    ds_write_b32 v42, v64 offset:0
    ds_write_b32 v42, v80 offset:128
    ds_write_b32 v42, v96 offset:256
    s_waitcnt lgkmcnt(0)
    s_barrier
    s_min_u32 s50, s49, 2
    s_lshl_b32 s50, s50, 7
    v_add_u32 v41, s50, v41
    v_add_u32 v42, 162304, v41
    ds_read_b32 v16, v42 offset:0
    ds_read_b32 v17, v42 offset:384
    ds_read_b32 v18, v42 offset:768
    ds_read_b32 v19, v42 offset:1152
    v_add_u32 v41, 159744, v41
    s_waitcnt lgkmcnt(0)
    v_add_f32 v16, v16, v17
    v_add_f32 v18, v18, v19
    v_add_f32 v16, v16, v18
    ds_write_b32 v41, v16
    v_mov_b32 v61, 161168
    ds_read_b32 v60, v61
    s_mul_i32 s50, s49, 24576
    v_add_u32 v42, s50, v1
    ds_read_b128 v[128:131], v42 offset:0
    ds_read_b128 v[132:135], v42 offset:1024
    ds_read_b128 v[136:139], v42 offset:2048
    ds_read_b128 v[140:143], v42 offset:3072
    ds_read_b128 v[144:147], v42 offset:4096
    ds_read_b128 v[148:151], v42 offset:5120
    ds_read_b128 v[152:155], v42 offset:6144
    ds_read_b128 v[156:159], v42 offset:7168
    ds_read_b128 v[160:163], v42 offset:8192
    ds_read_b128 v[164:167], v42 offset:9216
    ds_read_b128 v[168:171], v42 offset:10240
    ds_read_b128 v[172:175], v42 offset:11264
    ds_read_b128 v[176:179], v42 offset:12288
    ds_read_b128 v[180:183], v42 offset:13312
    ds_read_b128 v[184:187], v42 offset:14336
    ds_read_b128 v[188:191], v42 offset:15360
    ds_read_b128 v[192:195], v42 offset:16384
    ds_read_b128 v[196:199], v42 offset:17408
    ds_read_b128 v[200:203], v42 offset:18432
    ds_read_b128 v[204:207], v42 offset:19456
    ds_read_b128 v[208:211], v42 offset:20480
    ds_read_b128 v[212:215], v42 offset:21504
    ds_read_b128 v[216:219], v42 offset:22528
    ds_read_b128 v[220:223], v42 offset:23552
    s_waitcnt lgkmcnt(15)
    v_readfirstlane_b32 s3, v60
    s_branch L_qh2_46
L_qh1_45:
    s_waitcnt lgkmcnt(0)
    s_barrier
L_qh2_46:
    v_subrev_u32 v20, 16, v0
    v_lshrrev_b32 v21, 3, v20
    v_lshlrev_b32 v21, 10, v21
    v_lshl_add_u32 v20, v20, 7, v21
    s_lshr_b32 s51, s42, 1
    s_and_b32 s52, s42, 1
    s_mov_b32 s53, 0x8400
    s_mul_i32 s59, s51, 8192
    s_add_u32 s53, s53, s59
    s_mul_i32 s59, s52, -1024
    s_add_u32 s53, s53, s59
    s_mul_i32 s59, s42, -2048
    s_add_u32 s53, s53, s59
    v_add_u32 v20, s53, v20
    v_lshlrev_b32 v19, 7, v0
    v_cmp_lt_u32 vcc, 15, v0
    s_add_u32 s50, s37, 0x90000
    s_mul_i32 s59, s41, 99328
    s_add_u32 s50, s50, s59
    s_mul_i32 s59, s42, 2048
    s_add_u32 s50, s50, s59
    v_cndmask_b32 v19, v19, v20, vcc
    s_waitcnt lgkmcnt(0)
    s_barrier
    s_barrier
    s_mov_b32 exec_hi, 0xffff
    buffer_load_dword v21, v19, s[4:7], s50 offen sc1
    s_mov_b64 exec, -1
    s_cmp_lg_u32 s36, 0
    s_cbranch_scc1 L_qkv_done_15
    s_mov_b32 s8, s22
    s_and_b32 s9, s23, 0xffff
    s_mov_b32 s10, 0xac0
    s_mov_b32 s11, 0x20000
    v_and_b32 v19, 31, v0
    v_lshlrev_b32 v19, 1, v19
    s_mov_b32 s50, 0x0
    s_mul_i32 s59, s49, 64
    s_add_u32 s50, s50, s59
    s_mul_i32 s59, s42, 192
    s_add_u32 s50, s50, s59
    buffer_load_ushort v224, v19, s[8:11], s50 offen
    s_mov_b32 s8, s26
    s_and_b32 s9, s27, 0xffff
    s_mov_b32 s10, 0x400
    s_mov_b32 s11, 0x20000
    s_and_b32 s54, s49, 1
    s_mov_b32 s50, 0x0
    s_mul_i32 s59, s54, 64
    s_add_u32 s50, s50, s59
    s_mul_i32 s59, s44, 128
    s_add_u32 s50, s50, s59
    buffer_load_ushort v225, v19, s[8:11], s50 offen
L_qkv_done_15:
    v_and_b32 v92, 27, v0
    v_cmp_eq_u32 vcc, 16, v92
    v_mov_b32 v93, 0x3f803f80
    s_nop 0
    v_mov_b32 v48, 0
    v_cndmask_b32 v76, 0, v93, vcc
    v_mov_b32 v49, 0
    v_cndmask_b32 v77, 0, v93, vcc
    v_mov_b32 v50, 0
    v_cndmask_b32 v78, 0, v93, vcc
    v_mov_b32 v51, 0
    v_cndmask_b32 v79, 0, v93, vcc
    v_mov_b32 v52, 0
    v_cndmask_b32 v80, 0, v93, vcc
    v_mov_b32 v53, 0
    v_cndmask_b32 v81, 0, v93, vcc
    v_mov_b32 v54, 0
    v_cndmask_b32 v82, 0, v93, vcc
    v_mov_b32 v55, 0
    v_cndmask_b32 v83, 0, v93, vcc
    v_mov_b32 v56, 0
    v_cndmask_b32 v84, 0, v93, vcc
    v_mov_b32 v57, 0
    v_cndmask_b32 v85, 0, v93, vcc
    v_mov_b32 v58, 0
    v_cndmask_b32 v86, 0, v93, vcc
    v_mov_b32 v59, 0
    v_cndmask_b32 v87, 0, v93, vcc
    v_mov_b32 v60, 0
    v_cndmask_b32 v88, 0, v93, vcc
    v_mov_b32 v61, 0
    v_cndmask_b32 v89, 0, v93, vcc
    v_mov_b32 v62, 0
    v_cndmask_b32 v90, 0, v93, vcc
    v_mov_b32 v63, 0
    v_cndmask_b32 v91, 0, v93, vcc
    v_mov_b32 v40, 0
    v_mov_b32 v41, 0
    v_mov_b32 v42, 0
    v_mov_b32 v43, 0
    v_mov_b32 v44, 0
    v_mov_b32 v45, 0
    v_mov_b32 v46, 0
    v_mov_b32 v47, 0
    v_mov_b32 v92, 0xdddddddd
    v_bfe_u32 v106, v0, 1, 4
    v_lshlrev_b32 v106, 13, v106
    v_and_b32 v105, 1, v0
    v_lshl_or_b32 v106, v105, 10, v106
    v_mov_b32 v93, v1
    v_lshrrev_b32 v94, 3, v0
    v_mul_u32_u24 v94, 1024, v94
    v_and_b32 v6, 7, v0
    v_lshrrev_b32 v7, 2, v0
    v_and_b32 v7, 4, v7
    v_xor_b32 v6, v6, v7
    v_lshl_or_b32 v94, v6, 4, v94
    v_add_u32 v6, 0, v0
    v_mul_u32_u24 v7, 5462, v6
    v_lshrrev_b32 v7, 16, v7
    v_mul_u32_u24 v95, 2560, v7
    v_lshl_add_u32 v95, v6, 4, v95
    v_add_u32 v6, 64, v0
    v_mul_u32_u24 v7, 5462, v6
    v_lshrrev_b32 v7, 16, v7
    v_mul_u32_u24 v96, 2560, v7
    v_lshl_add_u32 v96, v6, 4, v96
    v_add_u32 v6, 128, v0
    v_mul_u32_u24 v7, 5462, v6
    v_lshrrev_b32 v7, 16, v7
    v_mul_u32_u24 v97, 2560, v7
    v_lshl_add_u32 v97, v6, 4, v97
    s_mov_b32 s56, 2
    v_lshlrev_b32 v100, 7, v0
    s_mov_b32 s66, 1409024
    s_mov_b32 s51, 5504
    s_cmp_eq_u32 s34, 2
    s_cselect_b64 s[64:65], s[20:21], s[24:25]
    s_cmp_eq_u32 s34, 1
    s_cselect_b64 s[64:65], s[16:17], s[64:65]
    s_cselect_b32 s66, 524288, s66
    s_cselect_b32 s51, 2048, s51
    s_and_b32 s65, s65, 0xffff
    s_mov_b32 s67, 0x20000
    s_mul_i32 s51, s51, s2
    s_cmp_eq_u32 s36, 0
    s_cselect_b32 s58, 2, 99
    s_cmp_eq_u32 s34, 0
    s_cselect_b32 s58, 99, s58
    s_mov_b32 s8, s20
    s_and_b32 s9, s21, 0xffff
    s_mov_b32 s10, 0x158000
    s_mov_b32 s11, 0x20000
    s_lshr_b32 s50, s40, 4
    s_mov_b32 s57, 0x80
    s_mul_i32 s59, s50, 128
    s_add_u32 s57, s57, s59
    s_mul_i32 s59, s49, 32
    s_add_u32 s57, s57, s59
    s_cmp_eq_u32 s57, 352
    s_cselect_b32 s57, 480, s57
    s_mul_i32 s57, s57, 2752
    s_mul_i32 s50, s42, 192
    s_add_u32 s57, s57, s50
    v_lshrrev_b32 v101, 1, v0
    v_mul_u32_u24 v101, 2752, v101
    v_and_b32 v102, 1, v0
    v_lshl_add_u32 v101, v102, 7, v101
    s_cmp_lt_u32 s34, 4
    s_cbranch_scc1 L_a1_51
    v_and_b32 v4, 15, v0
    v_lshlrev_b32 v4, 3, v4
    s_lshr_b32 s51, s47, 2
    s_lshl_b32 s51, s51, 1
    s_mov_b32 s55, 0xa00000
    s_mul_i32 s59, s36, 1048576
    s_add_u32 s55, s55, s59
    s_mul_i32 s59, s51, 65536
    s_add_u32 s55, s55, s59
    s_mul_i32 s59, s39, 128
    s_add_u32 s55, s55, s59
    s_mul_i32 s59, s49, 2048
    s_add_u32 s55, s55, s59
    s_add_u32 s50, s38, 1024
    s_mul_i32 s59, s51, 64
    s_add_u32 s50, s50, s59
    s_add_u32 s51, s37, 0x90000
    s_mul_i32 s59, s47, 1024
    s_add_u32 s51, s51, s59
    s_mul_i32 s59, s49, 198656
    s_add_u32 s51, s51, s59
    s_mov_b32 s52, 0x200000
    s_mul_i32 s59, s36, 4194304
    s_add_u32 s52, s52, s59
    s_mul_i32 s59, s47, 131072
    s_add_u32 s52, s52, s59
    s_mul_i32 s59, s49, 4096
    s_add_u32 s52, s52, s59
    s_add_u32 s58, s37, 0x98000
    s_mul_i32 s59, s47, 2048
    s_add_u32 s58, s58, s59
    s_mul_i32 s59, s49, 198656
    s_add_u32 s58, s58, s59
    s_mov_b32 s57, 0x20000
    s_mul_i32 s59, s49, 2048
    s_add_u32 s57, s57, s59
    s_lshl_b32 s53, s49, 12
    s_add_u32 s54, s39, 1
    s_mov_b32 s56, 0
    s_barrier
    s_mov_b32 s60, 65536
    buffer_load_dwordx2 v[6:7], v4, s[4:7], s50 offen sc1
L_poll_52:
    buffer_load_dwordx2 v[16:17], v4, s[4:7], s50 offen sc1
    s_waitcnt vmcnt(1)
    v_cmp_eq_u64 vcc, v[6:7], v[2:3]
    s_nop 0
    s_cmp_eq_u64 vcc, -1
    s_cbranch_scc1 L_pok_53
    buffer_load_dwordx2 v[6:7], v4, s[4:7], s50 offen sc1
    s_waitcnt vmcnt(1)
    v_cmp_eq_u64 vcc, v[16:17], v[2:3]
    s_nop 0
    s_cmp_eq_u64 vcc, -1
    s_cbranch_scc1 L_pok_53
    s_sub_u32 s60, s60, 1
    s_cbranch_scc0 L_poll_52
    s_endpgm
L_pok_53:
    s_add_u32 m0, s53, 0
    s_nop 0
    buffer_load_dwordx4 v1, s[4:7], s58 offen offset:0 sc1 lds
    buffer_load_dwordx4 v1, s[4:7], s58 offen offset:1024 sc1 lds
    s_add_u32 m0, s57, 0
    s_add_u32 s58, s58, 99328
    buffer_load_dwordx4 v1, s[4:7], s51 offen sc1 lds
    s_add_u32 s51, s51, 99328
    s_add_u32 m0, s53, 2048
    s_nop 0
    buffer_load_dwordx4 v1, s[4:7], s58 offen offset:0 sc1 lds
    buffer_load_dwordx4 v1, s[4:7], s58 offen offset:1024 sc1 lds
    s_add_u32 m0, s57, 1024
    s_add_u32 s58, s58, 99328
    buffer_load_dwordx4 v1, s[4:7], s51 offen sc1 lds
    s_add_u32 s51, s51, 99328
    s_waitcnt vmcnt(0)
    buffer_load_dwordx2 v[6:7], v106, s[4:7], s55 offen sc1
L_a1_51:
    s_mov_b32 s50, 0x20000
    s_mul_i32 s59, s34, 1024
    s_add_u32 s50, s50, s59
    v_add_u32 v16, s50, v1
    s_barrier
    ds_read_b128 v[64:67], v16
    ds_read_b128 v[68:71], v93 offset:0
    s_mov_b64 exec, s[62:63]
    ds_read_b128 v[76:79], v93 offset:1024
    ds_read_b128 v[80:83], v93 offset:1280
    s_mov_b64 exec, -1
    ds_read_b128 v[72:75], v93 offset:2048
    s_waitcnt lgkmcnt(3)
    v_mfma_f32_32x32x16_bf16 v[16:31], v[68:71], v[64:67], 0
    s_mov_b32 s61, 0
    s_mov_b32 s60, 65536
    s_nop 8
.p2align 6
L_att_54:
    s_setprio 3
    s_cmp_eq_u32 s56, 0
    s_cbranch_scc1 L_chk_55
L_chkb_56:
    v_exp_f32 v16, v16
    v_exp_f32 v17, v17
    v_smfmac_f32_32x32x32_bf16 v[48:63], v[88:91], v[40:47], v92
    s_mov_b64 exec, s[62:63]
    ds_read_b128 v[84:87], v93 offset:3072
    ds_read_b128 v[88:91], v93 offset:3328
    s_mov_b64 exec, -1
    v_exp_f32 v18, v18
    v_exp_f32 v19, v19
    v_exp_f32 v20, v20
    v_exp_f32 v21, v21
    s_waitcnt lgkmcnt(2)
    v_mfma_f32_32x32x16_bf16 v[32:47], v[72:75], v[64:67], 0
    ds_read_b128 v[68:71], v93 offset:4096
    v_exp_f32 v22, v22
    v_exp_f32 v23, v23
    v_exp_f32 v24, v24
    v_exp_f32 v25, v25
    v_exp_f32 v26, v26
    v_exp_f32 v27, v27
    v_smfmac_f32_32x32x32_bf16 v[48:63], v[76:79], v[16:23], v92
    v_exp_f32 v28, v28
    v_exp_f32 v29, v29
    v_exp_f32 v30, v30
    v_exp_f32 v31, v31
    v_exp_f32 v32, v32
    v_exp_f32 v33, v33
    v_smfmac_f32_32x32x32_bf16 v[48:63], v[80:83], v[24:31], v92
    s_mov_b64 exec, s[62:63]
    ds_read_b128 v[76:79], v93 offset:5120
    ds_read_b128 v[80:83], v93 offset:5376
    s_mov_b64 exec, -1
    v_exp_f32 v34, v34
    v_exp_f32 v35, v35
    v_exp_f32 v36, v36
    v_exp_f32 v37, v37
    s_waitcnt lgkmcnt(2)
    v_mfma_f32_32x32x16_bf16 v[16:31], v[68:71], v[64:67], 0
    ds_read_b128 v[72:75], v93 offset:6144
    s_cmp_lt_u32 s34, 4
    s_cbranch_scc1 L_kvc_59
    s_cmp_eq_u32 s61, 0
    s_cbranch_scc1 L_kvs_58
    s_and_b32 s54, s54, 7
    s_lshl_b32 s59, s54, 14
    s_add_u32 s53, s53, 16384
    s_add_u32 s59, s59, s52
    s_mov_b32 m0, s53
    s_add_u32 s54, s54, 1
    buffer_load_dwordx4 v1, s[4:7], s59 offen offset:0 sc1 nt lds
    buffer_load_dwordx4 v1, s[4:7], s59 offen offset:1024 sc1 nt lds
    buffer_load_dwordx4 v1, s[4:7], s59 offen offset:2048 sc1 nt lds
    buffer_load_dwordx4 v1, s[4:7], s59 offen offset:3072 sc1 nt lds
L_kvs_58:
    v_exp_f32 v38, v38
    v_exp_f32 v39, v39
    v_exp_f32 v40, v40
    v_exp_f32 v41, v41
    v_exp_f32 v42, v42
    v_exp_f32 v43, v43
    v_smfmac_f32_32x32x32_bf16 v[48:63], v[84:87], v[32:39], v92
    v_exp_f32 v44, v44
    v_exp_f32 v45, v45
    v_exp_f32 v46, v46
    v_exp_f32 v47, v47
    s_setprio 2
    v_exp_f32 v16, v16
    v_exp_f32 v17, v17
    v_smfmac_f32_32x32x32_bf16 v[48:63], v[88:91], v[40:47], v92
    s_mov_b64 exec, s[62:63]
    ds_read_b128 v[84:87], v93 offset:7168
    ds_read_b128 v[88:91], v93 offset:7424
    s_mov_b64 exec, -1
    v_exp_f32 v18, v18
    v_exp_f32 v19, v19
    v_exp_f32 v20, v20
    v_exp_f32 v21, v21
    s_waitcnt lgkmcnt(2)
    v_mfma_f32_32x32x16_bf16 v[32:47], v[72:75], v[64:67], 0
    ds_read_b128 v[68:71], v93 offset:8192
    v_exp_f32 v22, v22
    v_exp_f32 v23, v23
    v_exp_f32 v24, v24
    v_exp_f32 v25, v25
    v_exp_f32 v26, v26
    v_exp_f32 v27, v27
    v_smfmac_f32_32x32x32_bf16 v[48:63], v[76:79], v[16:23], v92
    v_exp_f32 v28, v28
    v_exp_f32 v29, v29
    v_exp_f32 v30, v30
    v_exp_f32 v31, v31
    v_exp_f32 v32, v32
    v_exp_f32 v33, v33
    v_smfmac_f32_32x32x32_bf16 v[48:63], v[80:83], v[24:31], v92
    s_mov_b64 exec, s[62:63]
    ds_read_b128 v[76:79], v93 offset:9216
    ds_read_b128 v[80:83], v93 offset:9472
    s_mov_b64 exec, -1
    v_exp_f32 v34, v34
    v_exp_f32 v35, v35
    v_exp_f32 v36, v36
    v_exp_f32 v37, v37
    s_waitcnt lgkmcnt(2)
    v_mfma_f32_32x32x16_bf16 v[16:31], v[68:71], v[64:67], 0
    ds_read_b128 v[72:75], v93 offset:10240
    v_exp_f32 v38, v38
    v_exp_f32 v39, v39
    v_exp_f32 v40, v40
    v_exp_f32 v41, v41
    v_exp_f32 v42, v42
    v_exp_f32 v43, v43
    v_smfmac_f32_32x32x32_bf16 v[48:63], v[84:87], v[32:39], v92
    v_exp_f32 v44, v44
    v_exp_f32 v45, v45
    v_exp_f32 v46, v46
    v_exp_f32 v47, v47
    s_setprio 1
    v_exp_f32 v16, v16
    v_exp_f32 v17, v17
    v_smfmac_f32_32x32x32_bf16 v[48:63], v[88:91], v[40:47], v92
    s_mov_b64 exec, s[62:63]
    ds_read_b128 v[84:87], v93 offset:11264
    ds_read_b128 v[88:91], v93 offset:11520
    s_mov_b64 exec, -1
    v_exp_f32 v18, v18
    v_exp_f32 v19, v19
    v_exp_f32 v20, v20
    v_exp_f32 v21, v21
    s_waitcnt lgkmcnt(2)
    v_mfma_f32_32x32x16_bf16 v[32:47], v[72:75], v[64:67], 0
    ds_read_b128 v[68:71], v93 offset:12288
    s_cmp_eq_u32 s56, 1
    s_cbranch_scc1 L_sc_62
L_scb_63:
    v_exp_f32 v22, v22
    v_exp_f32 v23, v23
    v_exp_f32 v24, v24
    v_exp_f32 v25, v25
    v_exp_f32 v26, v26
    v_exp_f32 v27, v27
    v_smfmac_f32_32x32x32_bf16 v[48:63], v[76:79], v[16:23], v92
    v_exp_f32 v28, v28
    v_exp_f32 v29, v29
    v_exp_f32 v30, v30
    v_exp_f32 v31, v31
    v_exp_f32 v32, v32
    v_exp_f32 v33, v33
    v_smfmac_f32_32x32x32_bf16 v[48:63], v[80:83], v[24:31], v92
    s_mov_b64 exec, s[62:63]
    ds_read_b128 v[76:79], v93 offset:13312
    ds_read_b128 v[80:83], v93 offset:13568
    s_mov_b64 exec, -1
    v_exp_f32 v34, v34
    v_exp_f32 v35, v35
    v_exp_f32 v36, v36
    v_exp_f32 v37, v37
    s_waitcnt lgkmcnt(2)
    v_mfma_f32_32x32x16_bf16 v[16:31], v[68:71], v[64:67], 0
    ds_read_b128 v[72:75], v93 offset:14336
    v_exp_f32 v38, v38
    v_exp_f32 v39, v39
    v_exp_f32 v40, v40
    v_exp_f32 v41, v41
    v_exp_f32 v42, v42
    v_exp_f32 v43, v43
    v_smfmac_f32_32x32x32_bf16 v[48:63], v[84:87], v[32:39], v92
    v_exp_f32 v44, v44
    v_exp_f32 v45, v45
    v_exp_f32 v46, v46
    v_exp_f32 v47, v47
    s_setprio 0
    s_waitcnt vmcnt(4)
    s_barrier
    v_exp_f32 v16, v16
    v_exp_f32 v17, v17
    v_smfmac_f32_32x32x32_bf16 v[48:63], v[88:91], v[40:47], v92
    s_mov_b64 exec, s[62:63]
    ds_read_b128 v[84:87], v93 offset:15360
    ds_read_b128 v[88:91], v93 offset:15616
    s_mov_b64 exec, -1
    v_exp_f32 v18, v18
    v_exp_f32 v19, v19
    v_exp_f32 v20, v20
    v_exp_f32 v21, v21
    s_waitcnt lgkmcnt(2)
    v_mfma_f32_32x32x16_bf16 v[32:47], v[72:75], v[64:67], 0
    ds_read_b128 v[68:71], v93 offset:16384
    v_exp_f32 v22, v22
    v_exp_f32 v23, v23
    v_exp_f32 v24, v24
    v_exp_f32 v25, v25
    v_exp_f32 v26, v26
    v_exp_f32 v27, v27
    v_smfmac_f32_32x32x32_bf16 v[48:63], v[76:79], v[16:23], v92
    v_exp_f32 v28, v28
    v_exp_f32 v29, v29
    v_exp_f32 v30, v30
    v_exp_f32 v31, v31
    v_exp_f32 v32, v32
    v_exp_f32 v33, v33
    v_smfmac_f32_32x32x32_bf16 v[48:63], v[80:83], v[24:31], v92
    s_mov_b64 exec, s[62:63]
    ds_read_b128 v[76:79], v93 offset:17408
    ds_read_b128 v[80:83], v93 offset:17664
    s_mov_b64 exec, -1
    v_exp_f32 v34, v34
    v_exp_f32 v35, v35
    v_exp_f32 v36, v36
    v_exp_f32 v37, v37
    s_waitcnt lgkmcnt(2)
    v_mfma_f32_32x32x16_bf16 v[16:31], v[68:71], v[64:67], 0
    ds_read_b128 v[72:75], v93 offset:18432
    v_exp_f32 v38, v38
    v_exp_f32 v39, v39
    v_exp_f32 v40, v40
    v_exp_f32 v41, v41
    v_exp_f32 v42, v42
    v_exp_f32 v43, v43
    v_smfmac_f32_32x32x32_bf16 v[48:63], v[84:87], v[32:39], v92
    v_exp_f32 v44, v44
    v_exp_f32 v45, v45
    v_exp_f32 v46, v46
    v_exp_f32 v47, v47
    v_add_u32 v93, 16384, v93
    s_add_u32 s61, s61, 1
    s_cmp_lt_u32 s61, 6
    s_cbranch_scc1 L_att_54
    s_mov_b32 s8, s16
    s_and_b32 s9, s17, 0xffff
    s_mov_b32 s10, 0x80000
    s_mov_b32 s11, 0x20000
    s_mov_b32 s50, 0x0
    s_mul_i32 s59, s34, 65536
    s_add_u32 s50, s50, s59
    s_mul_i32 s59, s44, 128
    s_add_u32 s50, s50, s59
    s_lshl_b32 s51, s34, 13
    s_mov_b32 s64, s24
    s_and_b32 s65, s25, 0xffff
    s_mov_b32 s66, 0x158000
    s_mov_b32 s67, 0x20000
    s_mov_b32 s52, 0x0
    s_mul_i32 s59, s40, 44032
    s_add_u32 s52, s52, s59
    s_mul_i32 s59, s34, 5504
    s_add_u32 s52, s52, s59
    s_setprio 3
    v_exp_f32 v16, v16
    v_exp_f32 v17, v17
    v_smfmac_f32_32x32x32_bf16 v[48:63], v[88:91], v[40:47], v92
    s_mov_b64 exec, s[62:63]
    ds_read_b128 v[84:87], v93 offset:3072
    ds_read_b128 v[88:91], v93 offset:3328
    s_mov_b64 exec, -1
    v_exp_f32 v18, v18
    v_exp_f32 v19, v19
    v_exp_f32 v20, v20
    v_exp_f32 v21, v21
    s_waitcnt lgkmcnt(2)
    v_mfma_f32_32x32x16_bf16 v[32:47], v[72:75], v[64:67], 0
    ds_read_b128 v[68:71], v93 offset:4096
    s_add_u32 m0, s51, 0
    s_nop 0
    buffer_load_dwordx4 v94, s[8:11], s50 offen lds
    s_add_u32 s50, s50, 8192
    v_exp_f32 v22, v22
    v_exp_f32 v23, v23
    v_exp_f32 v24, v24
    v_exp_f32 v25, v25
    v_exp_f32 v26, v26
    v_exp_f32 v27, v27
    v_smfmac_f32_32x32x32_bf16 v[48:63], v[76:79], v[16:23], v92
    v_exp_f32 v28, v28
    v_exp_f32 v29, v29
    v_exp_f32 v30, v30
    v_exp_f32 v31, v31
    v_exp_f32 v32, v32
    v_exp_f32 v33, v33
    v_smfmac_f32_32x32x32_bf16 v[48:63], v[80:83], v[24:31], v92
    s_mov_b64 exec, s[62:63]
    ds_read_b128 v[76:79], v93 offset:5120
    ds_read_b128 v[80:83], v93 offset:5376
    s_mov_b64 exec, -1
    v_exp_f32 v34, v34
    v_exp_f32 v35, v35
    v_exp_f32 v36, v36
    v_exp_f32 v37, v37
    s_waitcnt lgkmcnt(2)
    v_mfma_f32_32x32x16_bf16 v[16:31], v[68:71], v[64:67], 0
    ds_read_b128 v[72:75], v93 offset:6144
    s_add_u32 m0, s51, 1024
    s_nop 0
    buffer_load_dwordx4 v94, s[8:11], s50 offen lds
    s_add_u32 s50, s50, 8192
    v_exp_f32 v38, v38
    v_exp_f32 v39, v39
    v_exp_f32 v40, v40
    v_exp_f32 v41, v41
    v_exp_f32 v42, v42
    v_exp_f32 v43, v43
    v_smfmac_f32_32x32x32_bf16 v[48:63], v[84:87], v[32:39], v92
    v_exp_f32 v44, v44
    v_exp_f32 v45, v45
    v_exp_f32 v46, v46
    v_exp_f32 v47, v47
    s_setprio 2
    v_exp_f32 v16, v16
    v_exp_f32 v17, v17
    v_smfmac_f32_32x32x32_bf16 v[48:63], v[88:91], v[40:47], v92
    s_mov_b64 exec, s[62:63]
    ds_read_b128 v[84:87], v93 offset:7168
    ds_read_b128 v[88:91], v93 offset:7424
    s_mov_b64 exec, -1
    v_exp_f32 v18, v18
    v_exp_f32 v19, v19
    v_exp_f32 v20, v20
    v_exp_f32 v21, v21
    s_waitcnt lgkmcnt(2)
    v_mfma_f32_32x32x16_bf16 v[32:47], v[72:75], v[64:67], 0
    ds_read_b128 v[68:71], v93 offset:8192
    s_add_u32 m0, s51, 2048
    s_nop 0
    buffer_load_dwordx4 v94, s[8:11], s50 offen lds
    s_add_u32 s50, s50, 8192
    v_exp_f32 v22, v22
    v_exp_f32 v23, v23
    v_exp_f32 v24, v24
    v_exp_f32 v25, v25
    v_exp_f32 v26, v26
    v_exp_f32 v27, v27
    v_smfmac_f32_32x32x32_bf16 v[48:63], v[76:79], v[16:23], v92
    v_exp_f32 v28, v28
    v_exp_f32 v29, v29
    v_exp_f32 v30, v30
    v_exp_f32 v31, v31
    v_exp_f32 v32, v32
    v_exp_f32 v33, v33
    v_smfmac_f32_32x32x32_bf16 v[48:63], v[80:83], v[24:31], v92
    s_mov_b64 exec, s[62:63]
    ds_read_b128 v[76:79], v93 offset:9216
    ds_read_b128 v[80:83], v93 offset:9472
    s_mov_b64 exec, -1
    v_exp_f32 v34, v34
    v_exp_f32 v35, v35
    v_exp_f32 v36, v36
    v_exp_f32 v37, v37
    s_waitcnt lgkmcnt(2)
    v_mfma_f32_32x32x16_bf16 v[16:31], v[68:71], v[64:67], 0
    ds_read_b128 v[72:75], v93 offset:10240
    s_add_u32 m0, s51, 3072
    s_nop 0
    buffer_load_dwordx4 v94, s[8:11], s50 offen lds
    s_add_u32 s50, s50, 8192
    v_exp_f32 v38, v38
    v_exp_f32 v39, v39
    v_exp_f32 v40, v40
    v_exp_f32 v41, v41
    v_exp_f32 v42, v42
    v_exp_f32 v43, v43
    v_smfmac_f32_32x32x32_bf16 v[48:63], v[84:87], v[32:39], v92
    v_exp_f32 v44, v44
    v_exp_f32 v45, v45
    v_exp_f32 v46, v46
    v_exp_f32 v47, v47
    s_setprio 1
    v_exp_f32 v16, v16
    v_exp_f32 v17, v17
    v_smfmac_f32_32x32x32_bf16 v[48:63], v[88:91], v[40:47], v92
    s_mov_b64 exec, s[62:63]
    ds_read_b128 v[84:87], v93 offset:11264
    ds_read_b128 v[88:91], v93 offset:11520
    s_mov_b64 exec, -1
    v_exp_f32 v18, v18
    v_exp_f32 v19, v19
    v_exp_f32 v20, v20
    v_exp_f32 v21, v21
    s_waitcnt lgkmcnt(2)
    v_mfma_f32_32x32x16_bf16 v[32:47], v[72:75], v[64:67], 0
    ds_read_b128 v[68:71], v93 offset:12288
    s_add_u32 m0, s51, 4096
    s_nop 0
    buffer_load_dwordx4 v94, s[8:11], s50 offen lds
    s_add_u32 s50, s50, 8192
    v_exp_f32 v22, v22
    v_exp_f32 v23, v23
    v_exp_f32 v24, v24
    v_exp_f32 v25, v25
    v_exp_f32 v26, v26
    v_exp_f32 v27, v27
    v_smfmac_f32_32x32x32_bf16 v[48:63], v[76:79], v[16:23], v92
    v_exp_f32 v28, v28
    v_exp_f32 v29, v29
    v_exp_f32 v30, v30
    v_exp_f32 v31, v31
    v_exp_f32 v32, v32
    v_exp_f32 v33, v33
    v_smfmac_f32_32x32x32_bf16 v[48:63], v[80:83], v[24:31], v92
    s_mov_b64 exec, s[62:63]
    ds_read_b128 v[76:79], v93 offset:13312
    ds_read_b128 v[80:83], v93 offset:13568
    s_mov_b64 exec, -1
    v_exp_f32 v34, v34
    v_exp_f32 v35, v35
    v_exp_f32 v36, v36
    v_exp_f32 v37, v37
    s_waitcnt lgkmcnt(2)
    v_mfma_f32_32x32x16_bf16 v[16:31], v[68:71], v[64:67], 0
    ds_read_b128 v[72:75], v93 offset:14336
    s_add_u32 m0, s51, 5120
    s_nop 0
    buffer_load_dwordx4 v94, s[8:11], s50 offen lds
    s_add_u32 s50, s50, 8192
    v_exp_f32 v38, v38
    v_exp_f32 v39, v39
    v_exp_f32 v40, v40
    v_exp_f32 v41, v41
    v_exp_f32 v42, v42
    v_exp_f32 v43, v43
    v_smfmac_f32_32x32x32_bf16 v[48:63], v[84:87], v[32:39], v92
    v_exp_f32 v44, v44
    v_exp_f32 v45, v45
    v_exp_f32 v46, v46
    v_exp_f32 v47, v47
    s_setprio 0
    s_waitcnt vmcnt(6)
    s_barrier
    v_exp_f32 v16, v16
    v_exp_f32 v17, v17
    v_smfmac_f32_32x32x32_bf16 v[48:63], v[88:91], v[40:47], v92
    s_mov_b64 exec, s[62:63]
    ds_read_b128 v[84:87], v93 offset:15360
    ds_read_b128 v[88:91], v93 offset:15616
    s_mov_b64 exec, -1
    v_exp_f32 v18, v18
    v_exp_f32 v19, v19
    v_exp_f32 v20, v20
    v_exp_f32 v21, v21
    s_waitcnt lgkmcnt(2)
    v_mfma_f32_32x32x16_bf16 v[32:47], v[72:75], v[64:67], 0
    ds_read_b128 v[68:71], v93 offset:16384
    s_add_u32 m0, s51, 6144
    s_nop 0
    buffer_load_dwordx4 v94, s[8:11], s50 offen lds
    s_add_u32 s50, s50, 8192
    v_exp_f32 v22, v22
    v_exp_f32 v23, v23
    v_exp_f32 v24, v24
    v_exp_f32 v25, v25
    v_exp_f32 v26, v26
    v_exp_f32 v27, v27
    v_smfmac_f32_32x32x32_bf16 v[48:63], v[76:79], v[16:23], v92
    v_exp_f32 v28, v28
    v_exp_f32 v29, v29
    v_exp_f32 v30, v30
    v_exp_f32 v31, v31
    v_exp_f32 v32, v32
    v_exp_f32 v33, v33
    v_smfmac_f32_32x32x32_bf16 v[48:63], v[80:83], v[24:31], v92
    s_mov_b64 exec, s[62:63]
    ds_read_b128 v[76:79], v93 offset:17408
    ds_read_b128 v[80:83], v93 offset:17664
    s_mov_b64 exec, -1
    v_exp_f32 v34, v34
    v_exp_f32 v35, v35
    v_exp_f32 v36, v36
    v_exp_f32 v37, v37
    s_waitcnt lgkmcnt(2)
    v_mfma_f32_32x32x16_bf16 v[16:31], v[68:71], v[64:67], 0
    ds_read_b128 v[72:75], v93 offset:18432
    s_add_u32 m0, s51, 7168
    s_nop 0
    buffer_load_dwordx4 v94, s[8:11], s50 offen lds
    s_add_u32 s50, s50, 8192
    v_exp_f32 v38, v38
    v_exp_f32 v39, v39
    v_exp_f32 v40, v40
    v_exp_f32 v41, v41
    v_exp_f32 v42, v42
    v_exp_f32 v43, v43
    v_smfmac_f32_32x32x32_bf16 v[48:63], v[84:87], v[32:39], v92
    v_exp_f32 v44, v44
    v_exp_f32 v45, v45
    v_exp_f32 v46, v46
    v_exp_f32 v47, v47
    s_add_u32 s54, s37, 0x48000
    s_mul_i32 s59, s34, 33792
    s_add_u32 s54, s54, s59
    s_mul_i32 s59, s47, 1024
    s_add_u32 s54, s54, s59
    s_add_u32 s55, s38, 2048
    s_mul_i32 s59, s34, 256
    s_add_u32 s55, s55, s59
    s_mul_i32 s59, s47, 8
    s_add_u32 s55, s55, s59
    s_mov_b32 s8, s20
    s_and_b32 s9, s21, 0xffff
    s_mov_b32 s10, 0x158000
    s_mov_b32 s11, 0x20000
    s_mov_b32 s50, 0x0
    s_mul_i32 s59, s34, 44032
    s_add_u32 s50, s50, s59
    s_mul_i32 s59, s42, 192
    s_add_u32 s50, s50, s59
    s_mov_b32 s51, 0x10000
    s_mul_i32 s59, s34, 3072
    s_add_u32 s51, s51, s59
    s_setprio 3
    v_exp_f32 v16, v16
    v_exp_f32 v17, v17
    v_smfmac_f32_32x32x32_bf16 v[48:63], v[88:91], v[40:47], v92
    s_mov_b64 exec, s[62:63]
    ds_read_b128 v[84:87], v93 offset:19456
    ds_read_b128 v[88:91], v93 offset:19712
    s_mov_b64 exec, -1
    v_exp_f32 v18, v18
    v_exp_f32 v19, v19
    v_exp_f32 v20, v20
    v_exp_f32 v21, v21
    s_waitcnt lgkmcnt(2)
    v_mfma_f32_32x32x16_bf16 v[32:47], v[72:75], v[64:67], 0
    ds_read_b128 v[68:71], v93 offset:20480
    s_add_u32 m0, s51, 0
    s_nop 0
    buffer_load_dwordx4 v95, s[8:11], s50 offen lds
    s_add_u32 m0, s51, 1024
    s_nop 0
    buffer_load_dwordx4 v96, s[8:11], s50 offen lds
    v_exp_f32 v22, v22
    v_exp_f32 v23, v23
    v_exp_f32 v24, v24
    v_exp_f32 v25, v25
    v_exp_f32 v26, v26
    v_exp_f32 v27, v27
    v_smfmac_f32_32x32x32_bf16 v[48:63], v[76:79], v[16:23], v92
    v_exp_f32 v28, v28
    v_exp_f32 v29, v29
    v_exp_f32 v30, v30
    v_exp_f32 v31, v31
    v_exp_f32 v32, v32
    v_exp_f32 v33, v33
    v_smfmac_f32_32x32x32_bf16 v[48:63], v[80:83], v[24:31], v92
    s_mov_b64 exec, s[62:63]
    ds_read_b128 v[76:79], v93 offset:21504
    ds_read_b128 v[80:83], v93 offset:21760
    s_mov_b64 exec, -1
    v_exp_f32 v34, v34
    v_exp_f32 v35, v35
    v_exp_f32 v36, v36
    v_exp_f32 v37, v37
    s_waitcnt lgkmcnt(2)
    v_mfma_f32_32x32x16_bf16 v[16:31], v[68:71], v[64:67], 0
    ds_read_b128 v[72:75], v93 offset:22528
    s_mov_b64 exec, 0x3fffff
    buffer_load_dword v102, v100, s[64:67], s52 offen
    s_mov_b64 exec, -1
    s_add_u32 s52, s52, 2816
    s_add_u32 m0, s51, 2048
    s_nop 0
    buffer_load_dwordx4 v97, s[8:11], s50 offen lds
    s_add_u32 s50, s50, 968704
    s_add_u32 m0, s51, 67584
    s_nop 0
    buffer_load_dwordx4 v95, s[8:11], s50 offen lds
    v_exp_f32 v38, v38
    v_exp_f32 v39, v39
    v_exp_f32 v40, v40
    v_exp_f32 v41, v41
    v_exp_f32 v42, v42
    v_exp_f32 v43, v43
    v_smfmac_f32_32x32x32_bf16 v[48:63], v[84:87], v[32:39], v92
    v_exp_f32 v44, v44
    v_exp_f32 v45, v45
    v_exp_f32 v46, v46
    v_exp_f32 v47, v47
    v_exp_f32 v16, v16
    v_exp_f32 v17, v17
    v_smfmac_f32_32x32x32_bf16 v[48:63], v[88:91], v[40:47], v92
    s_mov_b64 exec, s[62:63]
    ds_read_b128 v[84:87], v93 offset:23552
    ds_read_b128 v[88:91], v93 offset:23808
    s_mov_b64 exec, -1
    v_exp_f32 v18, v18
    v_exp_f32 v19, v19
    v_exp_f32 v20, v20
    v_exp_f32 v21, v21
    s_waitcnt lgkmcnt(2)
    v_mfma_f32_32x32x16_bf16 v[32:47], v[72:75], v[64:67], 0
    ds_read_b128 v[68:71], v93 offset:24576
    s_add_u32 m0, s51, 68608
    s_nop 0
    buffer_load_dwordx4 v96, s[8:11], s50 offen lds
    v_exp_f32 v22, v22
    v_exp_f32 v23, v23
    v_exp_f32 v24, v24
    v_exp_f32 v25, v25
    v_exp_f32 v26, v26
    v_exp_f32 v27, v27
    v_smfmac_f32_32x32x32_bf16 v[48:63], v[76:79], v[16:23], v92
    v_exp_f32 v28, v28
    v_exp_f32 v29, v29
    v_exp_f32 v30, v30
    v_exp_f32 v31, v31
    v_exp_f32 v32, v32
    v_exp_f32 v33, v33
    v_smfmac_f32_32x32x32_bf16 v[48:63], v[80:83], v[24:31], v92
    s_mov_b64 exec, s[62:63]
    ds_read_b128 v[76:79], v93 offset:25600
    ds_read_b128 v[80:83], v93 offset:25856
    s_mov_b64 exec, -1
    v_exp_f32 v34, v34
    v_exp_f32 v35, v35
    v_exp_f32 v36, v36
    v_exp_f32 v37, v37
    s_waitcnt lgkmcnt(2)
    v_mfma_f32_32x32x16_bf16 v[16:31], v[68:71], v[64:67], 0
    ds_read_b128 v[72:75], v93 offset:26624
    s_mov_b64 exec, 0x3fffff
    buffer_load_dword v102, v100, s[64:67], s52 offen
    s_mov_b64 exec, -1
    s_add_u32 s52, s52, 2816
    s_add_u32 m0, s51, 69632
    s_nop 0
    buffer_load_dwordx4 v97, s[8:11], s50 offen lds
    v_exp_f32 v38, v38
    v_exp_f32 v39, v39
    v_exp_f32 v40, v40
    v_exp_f32 v41, v41
    v_exp_f32 v42, v42
    v_exp_f32 v43, v43
    v_smfmac_f32_32x32x32_bf16 v[48:63], v[84:87], v[32:39], v92
    v_exp_f32 v44, v44
    v_exp_f32 v45, v45
    v_exp_f32 v46, v46
    v_exp_f32 v47, v47
    s_setprio 2
    v_exp_f32 v16, v16
    v_exp_f32 v17, v17
    v_smfmac_f32_32x32x32_bf16 v[48:63], v[88:91], v[40:47], v92
    s_mov_b64 exec, s[62:63]
    ds_read_b128 v[84:87], v93 offset:27648
    ds_read_b128 v[88:91], v93 offset:27904
    s_mov_b64 exec, -1
    v_exp_f32 v18, v18
    v_exp_f32 v19, v19
    v_exp_f32 v20, v20
    v_exp_f32 v21, v21
    s_waitcnt lgkmcnt(2)
    v_mfma_f32_32x32x16_bf16 v[32:47], v[72:75], v[64:67], 0
    ds_read_b128 v[68:71], v93 offset:28672
    v_exp_f32 v22, v22
    v_exp_f32 v23, v23
    v_exp_f32 v24, v24
    v_exp_f32 v25, v25
    v_exp_f32 v26, v26
    v_exp_f32 v27, v27
    v_smfmac_f32_32x32x32_bf16 v[48:63], v[76:79], v[16:23], v92
    v_exp_f32 v28, v28
    v_exp_f32 v29, v29
    v_exp_f32 v30, v30
    v_exp_f32 v31, v31
    v_exp_f32 v32, v32
    v_exp_f32 v33, v33
    v_smfmac_f32_32x32x32_bf16 v[48:63], v[80:83], v[24:31], v92
    s_mov_b64 exec, s[62:63]
    ds_read_b128 v[76:79], v93 offset:29696
    ds_read_b128 v[80:83], v93 offset:29952
    s_mov_b64 exec, -1
    v_exp_f32 v34, v34
    v_exp_f32 v35, v35
    v_exp_f32 v36, v36
    v_exp_f32 v37, v37
    s_waitcnt lgkmcnt(2)
    v_mfma_f32_32x32x16_bf16 v[16:31], v[68:71], v[64:67], 0
    ds_read_b128 v[72:75], v93 offset:30720
    v_exp_f32 v38, v38
    v_exp_f32 v39, v39
    v_exp_f32 v40, v40
    v_exp_f32 v41, v41
    v_exp_f32 v42, v42
    v_exp_f32 v43, v43
    v_smfmac_f32_32x32x32_bf16 v[48:63], v[84:87], v[32:39], v92
    v_exp_f32 v44, v44
    v_exp_f32 v45, v45
    v_exp_f32 v46, v46
    v_exp_f32 v47, v47
    s_setprio 1
    v_exp_f32 v16, v16
    v_exp_f32 v17, v17
    v_smfmac_f32_32x32x32_bf16 v[48:63], v[88:91], v[40:47], v92
    s_mov_b64 exec, s[62:63]
    ds_read_b128 v[84:87], v93 offset:31744
    ds_read_b128 v[88:91], v93 offset:32000
    s_mov_b64 exec, -1
    v_exp_f32 v18, v18
    v_exp_f32 v19, v19
    v_exp_f32 v20, v20
    v_exp_f32 v21, v21
    s_waitcnt lgkmcnt(2)
    v_mfma_f32_32x32x16_bf16 v[32:47], v[72:75], v[64:67], 0
    ds_read_b128 v[68:71], v93 offset:32768
    v_exp_f32 v22, v22
    v_exp_f32 v23, v23
    v_exp_f32 v24, v24
    v_exp_f32 v25, v25
    v_exp_f32 v26, v26
    v_exp_f32 v27, v27
    v_smfmac_f32_32x32x32_bf16 v[48:63], v[76:79], v[16:23], v92
    v_exp_f32 v28, v28
    v_exp_f32 v29, v29
    v_exp_f32 v30, v30
    v_exp_f32 v31, v31
    s_setprio 0
    v_exp_f32 v32, v32
    v_exp_f32 v33, v33
    v_smfmac_f32_32x32x32_bf16 v[48:63], v[80:83], v[24:31], v92
    s_mov_b64 exec, s[62:63]
    ds_read_b128 v[76:79], v93 offset:33792
    ds_read_b128 v[80:83], v93 offset:34048
    s_mov_b64 exec, -1
    v_exp_f32 v34, v34
    v_exp_f32 v35, v35
    v_exp_f32 v36, v36
    v_exp_f32 v37, v37
    s_waitcnt lgkmcnt(2)
    v_mfma_f32_32x32x16_bf16 v[16:31], v[68:71], v[64:67], 0
    ds_read_b128 v[72:75], v93 offset:34816
    v_exp_f32 v38, v38
    v_exp_f32 v39, v39
    v_exp_f32 v40, v40
    v_exp_f32 v41, v41
    v_exp_f32 v42, v42
    v_exp_f32 v43, v43
    v_smfmac_f32_32x32x32_bf16 v[48:63], v[84:87], v[32:39], v92
    v_exp_f32 v44, v44
    v_exp_f32 v45, v45
    v_exp_f32 v46, v46
    v_exp_f32 v47, v47
    s_nop 1
    v_smfmac_f32_32x32x32_bf16 v[48:63], v[88:91], v[40:47], v92
    s_setprio 0
    s_mov_b32 s56, 0x1f800000
    s_mov_b32 s57, 0x5f800000
    s_waitcnt lgkmcnt(0)
    s_nop 7
    v_cmp_le_f32 s[64:65], s56, v56
    v_cmp_ge_f32 s[66:67], s57, v56
    v_pk_mul_f32 v[18:19], v[48:49], 0 op_sel_hi:[1,0]
    v_pk_fma_f32 v[18:19], v[50:51], 0, v[18:19] op_sel_hi:[1,0,1]
    v_pk_fma_f32 v[18:19], v[52:53], 0, v[18:19] op_sel_hi:[1,0,1]
    v_pk_fma_f32 v[18:19], v[54:55], 0, v[18:19] op_sel_hi:[1,0,1]
    s_and_b64 s[64:65], s[64:65], s[66:67]
    v_cmp_eq_f32 vcc, v18, v19
    s_nop 0
    s_and_b64 s[64:65], s[64:65], vcc
    s_cmp_eq_u64 s[64:65], -1
    s_cbranch_scc0 L_att_slow_65
L_att_fin_64:
    v_rcp_f32 v16, v56
    s_nop 0
    v_pk_mul_f32 v[48:49], v[48:49], v[16:17] op_sel_hi:[1,0]
    v_pk_mul_f32 v[50:51], v[50:51], v[16:17] op_sel_hi:[1,0]
    v_pk_mul_f32 v[52:53], v[52:53], v[16:17] op_sel_hi:[1,0]
    v_pk_mul_f32 v[54:55], v[54:55], v[16:17] op_sel_hi:[1,0]
    v_cvt_pk_bf16_f32 v20, v48, v49
    v_cvt_pk_bf16_f32 v21, v50, v51
    v_cvt_pk_bf16_f32 v22, v52, v53
    v_cvt_pk_bf16_f32 v23, v54, v55
    s_cmp_eq_u32 s3, 0
    s_cbranch_scc1 L_wt_66
    buffer_store_dwordx4 v[20:23], v1, s[4:7], s54 offen
L_wtd_67:
    s_cmp_ge_u32 s34, 4
    s_cbranch_scc1 L_ns_68
    v_lshlrev_b32 v144, 16, v8
    v_and_b32 v145, 0xffff0000, v8
    v_lshlrev_b32 v146, 16, v9
    v_and_b32 v147, 0xffff0000, v9
    v_lshlrev_b32 v148, 16, v10
    v_and_b32 v149, 0xffff0000, v10
    v_lshlrev_b32 v150, 16, v11
    v_and_b32 v151, 0xffff0000, v11
    v_lshlrev_b32 v152, 16, v12
    v_and_b32 v153, 0xffff0000, v12
    v_lshlrev_b32 v154, 16, v13
    v_and_b32 v155, 0xffff0000, v13
    v_lshlrev_b32 v156, 16, v14
    v_and_b32 v157, 0xffff0000, v14
    v_lshlrev_b32 v158, 16, v15
    v_and_b32 v159, 0xffff0000, v15
    v_bfe_u32 v244, v0, 2, 2
    v_lshrrev_b32 v6, 2, v255
    v_add_u32 v244, v244, v6
    v_mul_u32_u24 v244, 128, v244
    v_add_u32 v244, v244, v252
    v_bfe_u32 v6, v0, 3, 1
    v_xor_b32 v6, s45, v6
    v_lshl_or_b32 v244, v6, 6, v244
    s_mul_i32 s50, s45, 32768
    v_add_u32 v244, s50, v244
    v_xor_b32 v245, 64, v244
    v_and_b32 v4, 15, v0
    s_add_u32 s50, s38, 2048
    s_mul_i32 s59, s43, 256
    s_add_u32 s50, s50, s59
    s_mul_i32 s59, s45, 128
    s_add_u32 s50, s50, s59
    s_add_u32 s51, s37, 0x48000
    s_mul_i32 s59, s43, 33792
    s_add_u32 s51, s51, s59
    s_mul_i32 s59, s45, 16384
    s_add_u32 s51, s51, s59
    v_lshlrev_b32 v4, 3, v4
L_ns_68:
    s_waitcnt vmcnt(0)
    s_mov_b64 exec, 1
    s_cmp_eq_u32 s3, 0
    s_cbranch_scc1 L_wt_69
    buffer_store_dwordx2 v[2:3], off, s[4:7], s55
L_wtd_70:
    s_mov_b64 exec, -1
    s_waitcnt vmcnt(1)
    s_barrier
    s_cmp_ge_u32 s34, 4
    s_cbranch_scc1 L_n_h_73
    ds_read_b64_tr_b16 v[192:193], v244 offset:0
    ds_read_b64_tr_b16 v[194:195], v244 offset:1024
    ds_read_b64_tr_b16 v[196:197], v245 offset:0
    ds_read_b64_tr_b16 v[198:199], v245 offset:1024
    ds_read_b64_tr_b16 v[200:201], v244 offset:2048
    ds_read_b64_tr_b16 v[202:203], v244 offset:3072
    ds_read_b64_tr_b16 v[204:205], v245 offset:2048
    ds_read_b64_tr_b16 v[206:207], v245 offset:3072
    s_mov_b32 s60, 65536
    buffer_load_dwordx2 v[6:7], v4, s[4:7], s50 offen sc1
L_poll_75:
    buffer_load_dwordx2 v[16:17], v4, s[4:7], s50 offen sc1
    s_waitcnt vmcnt(1)
    v_cmp_eq_u64 vcc, v[6:7], v[2:3]
    s_nop 0
    s_cmp_eq_u64 vcc, -1
    s_cbranch_scc1 L_pok_76
    buffer_load_dwordx2 v[6:7], v4, s[4:7], s50 offen sc1
    s_waitcnt vmcnt(1)
    v_cmp_eq_u64 vcc, v[16:17], v[2:3]
    s_nop 0
    s_cmp_eq_u64 vcc, -1
    s_cbranch_scc1 L_pok_76
    s_sub_u32 s60, s60, 1
    s_cbranch_scc0 L_poll_75
    s_endpgm
L_pok_76:
    s_add_u32 s58, s51, 0
    buffer_load_dwordx4 v[16:19], v1, s[4:7], s58 offen offset:0 sc1
    buffer_load_dwordx4 v[20:23], v1, s[4:7], s58 offen offset:1024 sc1
    buffer_load_dwordx4 v[24:27], v1, s[4:7], s58 offen offset:2048 sc1
    buffer_load_dwordx4 v[28:31], v1, s[4:7], s58 offen offset:3072 sc1
    s_add_u32 s58, s51, 4096
    buffer_load_dwordx4 v[32:35], v1, s[4:7], s58 offen offset:0 sc1
    buffer_load_dwordx4 v[36:39], v1, s[4:7], s58 offen offset:1024 sc1
    buffer_load_dwordx4 v[40:43], v1, s[4:7], s58 offen offset:2048 sc1
    buffer_load_dwordx4 v[44:47], v1, s[4:7], s58 offen offset:3072 sc1
    s_add_u32 s58, s51, 8192
    buffer_load_dwordx4 v[48:51], v1, s[4:7], s58 offen offset:0 sc1
    buffer_load_dwordx4 v[52:55], v1, s[4:7], s58 offen offset:1024 sc1
    s_waitcnt vmcnt(9) lgkmcnt(4)
    v_mfma_f32_32x32x16_bf16 v[144:159], v[192:195], v[16:19], v[144:159]
    ds_read_b64_tr_b16 v[208:209], v244 offset:4096
    ds_read_b64_tr_b16 v[210:211], v244 offset:5120
    buffer_load_dwordx4 v[56:59], v1, s[4:7], s58 offen offset:2048 sc1
    v_mfma_f32_32x32x16_bf16 v[160:175], v[196:199], v[16:19], 0
    ds_read_b64_tr_b16 v[212:213], v245 offset:4096
    ds_read_b64_tr_b16 v[214:215], v245 offset:5120
    s_waitcnt vmcnt(9) lgkmcnt(4)
    v_mfma_f32_32x32x16_bf16 v[144:159], v[200:203], v[20:23], v[144:159]
    ds_read_b64_tr_b16 v[192:193], v244 offset:6144
    ds_read_b64_tr_b16 v[194:195], v244 offset:7168
    buffer_load_dwordx4 v[60:63], v1, s[4:7], s58 offen offset:3072 sc1
    v_mfma_f32_32x32x16_bf16 v[160:175], v[204:207], v[20:23], v[160:175]
    ds_read_b64_tr_b16 v[196:197], v245 offset:6144
    ds_read_b64_tr_b16 v[198:199], v245 offset:7168
    s_waitcnt vmcnt(9) lgkmcnt(4)
    v_mfma_f32_32x32x16_bf16 v[144:159], v[208:211], v[24:27], v[144:159]
    ds_read_b64_tr_b16 v[200:201], v244 offset:8192
    ds_read_b64_tr_b16 v[202:203], v244 offset:9216
    s_add_u32 s58, s51, 12288
    buffer_load_dwordx4 v[64:67], v1, s[4:7], s58 offen offset:0 sc1
    s_and_b32 s52, s34, 1
    s_mov_b32 s50, 0x0
    v_mfma_f32_32x32x16_bf16 v[160:175], v[212:215], v[24:27], v[160:175]
    ds_read_b64_tr_b16 v[204:205], v245 offset:8192
    ds_read_b64_tr_b16 v[206:207], v245 offset:9216
    s_mul_i32 s59, s52, 4096
    s_add_u32 s50, s50, s59
    s_waitcnt vmcnt(9) lgkmcnt(4)
    v_mfma_f32_32x32x16_bf16 v[144:159], v[192:195], v[28:31], v[144:159]
    ds_read_b64_tr_b16 v[208:209], v244 offset:10240
    ds_read_b64_tr_b16 v[210:211], v244 offset:11264
    buffer_load_dwordx4 v[68:71], v1, s[4:7], s58 offen offset:1024 sc1
    s_mul_i32 s59, s45, 32768
    s_add_u32 s50, s50, s59
    v_mfma_f32_32x32x16_bf16 v[160:175], v[196:199], v[28:31], v[160:175]
    ds_read_b64_tr_b16 v[212:213], v245 offset:10240
    ds_read_b64_tr_b16 v[214:215], v245 offset:11264
    s_xor_b32 s53, s50, 32768
    s_add_u32 s54, s37, 0x0
    s_waitcnt vmcnt(9) lgkmcnt(4)
    v_mfma_f32_32x32x16_bf16 v[144:159], v[200:203], v[32:35], v[144:159]
    ds_read_b64_tr_b16 v[192:193], v244 offset:12288
    ds_read_b64_tr_b16 v[194:195], v244 offset:13312
    buffer_load_dwordx4 v[72:75], v1, s[4:7], s58 offen offset:2048 sc1
    s_mul_i32 s59, s43, 33792
    s_add_u32 s54, s54, s59
    v_mfma_f32_32x32x16_bf16 v[160:175], v[204:207], v[32:35], v[160:175]
    ds_read_b64_tr_b16 v[196:197], v245 offset:12288
    ds_read_b64_tr_b16 v[198:199], v245 offset:13312
    s_mul_i32 s59, s46, 2048
    s_add_u32 s54, s54, s59
    s_waitcnt vmcnt(9) lgkmcnt(4)
    v_mfma_f32_32x32x16_bf16 v[144:159], v[208:211], v[36:39], v[144:159]
    ds_read_b64_tr_b16 v[200:201], v244 offset:14336
    ds_read_b64_tr_b16 v[202:203], v244 offset:15360
    buffer_load_dwordx4 v[76:79], v1, s[4:7], s58 offen offset:3072 sc1
    s_lshr_b32 s56, s46, 2
    s_and_b32 s57, s46, 3
    v_mfma_f32_32x32x16_bf16 v[160:175], v[212:215], v[36:39], v[160:175]
    ds_read_b64_tr_b16 v[204:205], v245 offset:14336
    ds_read_b64_tr_b16 v[206:207], v245 offset:15360
    s_add_u32 s55, s37, 0x158000
    s_mul_i32 s59, s43, 4096
    s_waitcnt vmcnt(9) lgkmcnt(4)
    v_mfma_f32_32x32x16_bf16 v[144:159], v[192:195], v[40:43], v[144:159]
    ds_read_b64_tr_b16 v[208:209], v244 offset:16384
    ds_read_b64_tr_b16 v[210:211], v244 offset:17408
    s_add_u32 s55, s55, s59
    s_mul_i32 s59, s56, 1024
    v_mfma_f32_32x32x16_bf16 v[160:175], v[196:199], v[40:43], v[160:175]
    ds_read_b64_tr_b16 v[212:213], v245 offset:16384
    ds_read_b64_tr_b16 v[214:215], v245 offset:17408
    s_add_u32 s55, s55, s59
    s_mul_i32 s59, s57, 4
    s_waitcnt vmcnt(8) lgkmcnt(4)
    v_mfma_f32_32x32x16_bf16 v[144:159], v[200:203], v[44:47], v[144:159]
    ds_read_b64_tr_b16 v[192:193], v244 offset:18432
    ds_read_b64_tr_b16 v[194:195], v244 offset:19456
    s_add_u32 s55, s55, s59
    s_add_u32 s56, s38, 4096
    v_mfma_f32_32x32x16_bf16 v[160:175], v[204:207], v[44:47], v[160:175]
    ds_read_b64_tr_b16 v[196:197], v245 offset:18432
    ds_read_b64_tr_b16 v[198:199], v245 offset:19456
    s_mul_i32 s59, s43, 128
    s_add_u32 s56, s56, s59
    s_waitcnt vmcnt(7) lgkmcnt(4)
    v_mfma_f32_32x32x16_bf16 v[144:159], v[208:211], v[48:51], v[144:159]
    ds_read_b64_tr_b16 v[200:201], v244 offset:20480
    ds_read_b64_tr_b16 v[202:203], v244 offset:21504
    s_mul_i32 s59, s46, 8
    s_add_u32 s56, s56, s59
    v_mfma_f32_32x32x16_bf16 v[160:175], v[212:215], v[48:51], v[160:175]
    ds_read_b64_tr_b16 v[204:205], v245 offset:20480
    ds_read_b64_tr_b16 v[206:207], v245 offset:21504
    v_add_u32 v4, s50, v1
    v_add_u32 v6, s53, v1
    s_barrier
    s_waitcnt vmcnt(6) lgkmcnt(4)
    v_mfma_f32_32x32x16_bf16 v[144:159], v[192:195], v[52:55], v[144:159]
    ds_read_b64_tr_b16 v[208:209], v244 offset:22528
    ds_read_b64_tr_b16 v[210:211], v244 offset:23552
    v_mfma_f32_32x32x16_bf16 v[160:175], v[196:199], v[52:55], v[160:175]
    ds_read_b64_tr_b16 v[212:213], v245 offset:22528
    ds_read_b64_tr_b16 v[214:215], v245 offset:23552
    s_waitcnt vmcnt(5) lgkmcnt(4)
    v_mfma_f32_32x32x16_bf16 v[144:159], v[200:203], v[56:59], v[144:159]
    ds_read_b64_tr_b16 v[192:193], v244 offset:24576
    ds_read_b64_tr_b16 v[194:195], v244 offset:25600
    v_mfma_f32_32x32x16_bf16 v[160:175], v[204:207], v[56:59], v[160:175]
    ds_read_b64_tr_b16 v[196:197], v245 offset:24576
    ds_read_b64_tr_b16 v[198:199], v245 offset:25600
    s_waitcnt vmcnt(4) lgkmcnt(4)
    v_mfma_f32_32x32x16_bf16 v[144:159], v[208:211], v[60:63], v[144:159]
    ds_read_b64_tr_b16 v[200:201], v244 offset:26624
    ds_read_b64_tr_b16 v[202:203], v244 offset:27648
    v_mfma_f32_32x32x16_bf16 v[160:175], v[212:215], v[60:63], v[160:175]
    ds_read_b64_tr_b16 v[204:205], v245 offset:26624
    ds_read_b64_tr_b16 v[206:207], v245 offset:27648
    s_waitcnt vmcnt(3) lgkmcnt(4)
    v_mfma_f32_32x32x16_bf16 v[144:159], v[192:195], v[64:67], v[144:159]
    ds_read_b64_tr_b16 v[208:209], v244 offset:28672
    ds_read_b64_tr_b16 v[210:211], v244 offset:29696
    v_mfma_f32_32x32x16_bf16 v[160:175], v[196:199], v[64:67], v[160:175]
    ds_read_b64_tr_b16 v[212:213], v245 offset:28672
    ds_read_b64_tr_b16 v[214:215], v245 offset:29696
    s_waitcnt vmcnt(2) lgkmcnt(4)
    v_mfma_f32_32x32x16_bf16 v[144:159], v[200:203], v[68:71], v[144:159]
    ds_read_b64_tr_b16 v[192:193], v244 offset:30720
    ds_read_b64_tr_b16 v[194:195], v244 offset:31744
    v_mfma_f32_32x32x16_bf16 v[160:175], v[204:207], v[68:71], v[160:175]
    ds_read_b64_tr_b16 v[196:197], v245 offset:30720
    ds_read_b64_tr_b16 v[198:199], v245 offset:31744
    s_waitcnt vmcnt(0) lgkmcnt(0)
    v_mfma_f32_32x32x16_bf16 v[160:175], v[212:215], v[72:75], v[160:175]
    v_mfma_f32_32x32x16_bf16 v[160:175], v[196:199], v[76:79], v[160:175]
    v_mfma_f32_32x32x16_bf16 v[144:159], v[208:211], v[72:75], v[144:159]
    v_mfma_f32_32x32x16_bf16 v[144:159], v[192:195], v[76:79], v[144:159]
    s_nop 9
    ds_write_b128 v4, v[160:163] offset:0
    ds_write_b128 v4, v[164:167] offset:1024
    ds_write_b128 v4, v[168:171] offset:2048
    ds_write_b128 v4, v[172:175] offset:3072
    s_waitcnt lgkmcnt(0)
    s_barrier
    ds_read_b128 v[160:163], v6 offset:0
    ds_read_b128 v[164:167], v6 offset:1024
    ds_read_b128 v[168:171], v6 offset:2048
    ds_read_b128 v[172:175], v6 offset:3072
    s_waitcnt lgkmcnt(3)
    v_pk_add_f32 v[144:145], v[144:145], v[160:161]
    v_pk_add_f32 v[146:147], v[146:147], v[162:163]
    s_waitcnt lgkmcnt(2)
    v_pk_add_f32 v[148:149], v[148:149], v[164:165]
    v_pk_add_f32 v[150:151], v[150:151], v[166:167]
    s_waitcnt lgkmcnt(1)
    v_pk_add_f32 v[152:153], v[152:153], v[168:169]
    v_pk_add_f32 v[154:155], v[154:155], v[170:171]
    s_waitcnt lgkmcnt(0)
    v_pk_add_f32 v[156:157], v[156:157], v[172:173]
    v_pk_add_f32 v[158:159], v[158:159], v[174:175]
    v_cvt_pk_bf16_f32 v8, v144, v145
    v_cvt_pk_bf16_f32 v9, v146, v147
    v_cvt_pk_bf16_f32 v10, v148, v149
    v_cvt_pk_bf16_f32 v11, v150, v151
    v_cvt_pk_bf16_f32 v12, v152, v153
    v_cvt_pk_bf16_f32 v13, v154, v155
    v_cvt_pk_bf16_f32 v14, v156, v157
    v_cvt_pk_bf16_f32 v15, v158, v159
    s_cmp_eq_u32 s3, 0
    s_cbranch_scc1 L_wt_77
    buffer_store_dwordx4 v[8:11], v1, s[4:7], s54 offen
    buffer_store_dwordx4 v[12:15], v1, s[4:7], s54 offen offset:1024
L_wtd_78:
    v_pk_add_f32 v[20:21], v[144:145], v[146:147]
    v_pk_mul_f32 v[22:23], v[144:145], v[144:145]
    v_pk_fma_f32 v[22:23], v[146:147], v[146:147], v[22:23]
    v_pk_add_f32 v[20:21], v[20:21], v[148:149]
    v_pk_fma_f32 v[22:23], v[148:149], v[148:149], v[22:23]
    v_pk_add_f32 v[20:21], v[20:21], v[150:151]
    v_pk_fma_f32 v[22:23], v[150:151], v[150:151], v[22:23]
    v_pk_add_f32 v[20:21], v[20:21], v[152:153]
    v_pk_fma_f32 v[22:23], v[152:153], v[152:153], v[22:23]
    v_pk_add_f32 v[20:21], v[20:21], v[154:155]
    v_pk_fma_f32 v[22:23], v[154:155], v[154:155], v[22:23]
    v_pk_add_f32 v[20:21], v[20:21], v[156:157]
    v_pk_fma_f32 v[22:23], v[156:157], v[156:157], v[22:23]
    v_pk_add_f32 v[20:21], v[20:21], v[158:159]
    v_pk_fma_f32 v[22:23], v[158:159], v[158:159], v[22:23]
    v_add_f32 v20, v20, v21
    v_add_f32 v22, v22, v23
    s_nop 1
    v_permlane32_swap_b32 v20, v22
    s_nop 1
    v_add_f32 v20, v20, v22
    s_cmp_eq_u32 s3, 0
    s_cbranch_scc1 L_wt_79
    buffer_store_dword v20, v1, s[4:7], s55 offen
L_wtd_80:
    v_and_b32 v4, 15, v0
    v_lshlrev_b32 v4, 3, v4
    s_add_u32 s50, s38, 4096
    s_mul_i32 s59, s41, 128
    s_add_u32 s50, s50, s59
    s_add_u32 s51, s37, 0x0
    s_mul_i32 s59, s41, 33792
    s_add_u32 s51, s51, s59
    s_add_u32 s52, s37, 0x158000
    s_mul_i32 s59, s41, 4096
    s_add_u32 s52, s52, s59
    v_add_u32 v251, 159744, v255
    v_bfe_u32 v247, v0, 2, 2
    v_lshrrev_b32 v6, 2, v255
    v_add_u32 v247, v247, v6
    v_mul_u32_u24 v247, 192, v247
    v_add_u32 v247, v247, v252
    v_add_u32 v244, 0x10000, v247
    v_add_u32 v245, 64512, v244
    s_waitcnt vmcnt(0)
    s_mov_b64 exec, 1
    s_cmp_eq_u32 s3, 0
    s_cbranch_scc1 L_wt_81
    buffer_store_dwordx2 v[2:3], off, s[4:7], s56
L_wtd_82:
    s_mov_b64 exec, -1
    s_branch L_n_done_74
L_n_h_73:
    v_add_u32 v6, 0, v0
    v_mul_u32_u24 v7, 5462, v6
    v_lshrrev_b32 v7, 16, v7
    v_mul_u32_u24 v44, 2560, v7
    v_lshl_add_u32 v44, v6, 4, v44
    v_add_u32 v6, 64, v0
    v_mul_u32_u24 v7, 5462, v6
    v_lshrrev_b32 v7, 16, v7
    v_mul_u32_u24 v45, 2560, v7
    v_lshl_add_u32 v45, v6, 4, v45
    v_add_u32 v6, 128, v0
    v_mul_u32_u24 v7, 5462, v6
    v_lshrrev_b32 v7, 16, v7
    v_mul_u32_u24 v46, 2560, v7
    v_lshl_add_u32 v46, v6, 4, v46
    s_lshl_b32 s53, s49, 2
    s_min_u32 s53, s53, 10
    s_mov_b32 s50, 0x56000
    s_mul_i32 s59, s53, 44032
    s_add_u32 s50, s50, s59
    s_mul_i32 s59, s42, 192
    s_add_u32 s50, s50, s59
    s_mov_b32 s51, 0x16000
    s_mul_i32 s59, s53, 3072
    s_add_u32 s51, s51, s59
    s_mov_b32 s53, s50
    s_mov_b32 s54, s51
    s_cmp_lg_u32 s36, 0
    s_cbranch_scc1 L_wcs_83
    v_bfe_u32 v43, v0, 2, 2
    v_lshrrev_b32 v6, 2, v255
    v_add_u32 v43, v43, v6
    v_mul_u32_u24 v43, 192, v43
    v_add_u32 v43, v43, v252
    v_mov_b32 v64, 0
    v_mov_b32 v65, 0
    v_mov_b32 v66, 0
    v_mov_b32 v67, 0
    v_mov_b32 v68, 0
    v_mov_b32 v69, 0
    v_mov_b32 v70, 0
    v_mov_b32 v71, 0
    v_mov_b32 v72, 0
    v_mov_b32 v73, 0
    v_mov_b32 v74, 0
    v_mov_b32 v75, 0
    v_mov_b32 v76, 0
    v_mov_b32 v77, 0
    v_mov_b32 v78, 0
    v_mov_b32 v79, 0
    v_mov_b32 v80, 0
    v_mov_b32 v81, 0
    v_mov_b32 v82, 0
    v_mov_b32 v83, 0
    v_mov_b32 v84, 0
    v_mov_b32 v85, 0
    v_mov_b32 v86, 0
    v_mov_b32 v87, 0
    v_mov_b32 v88, 0
    v_mov_b32 v89, 0
    v_mov_b32 v90, 0
    v_mov_b32 v91, 0
    v_mov_b32 v92, 0
    v_mov_b32 v93, 0
    v_mov_b32 v94, 0
    v_mov_b32 v95, 0
    v_mov_b32 v96, 0
    v_mov_b32 v97, 0
    v_mov_b32 v98, 0
    v_mov_b32 v99, 0
    v_mov_b32 v100, 0
    v_mov_b32 v101, 0
    v_mov_b32 v102, 0
    v_mov_b32 v103, 0
    v_mov_b32 v104, 0
    v_mov_b32 v105, 0
    v_mov_b32 v106, 0
    v_mov_b32 v107, 0
    v_mov_b32 v108, 0
    v_mov_b32 v109, 0
    v_mov_b32 v110, 0
    v_mov_b32 v111, 0
    v_mov_b32 v52, 0x3f803f80
    v_mov_b32 v53, 0x3f803f80
    v_mov_b32 v54, 0x3f803f80
    v_mov_b32 v55, 0x3f803f80
    s_mov_b32 s50, 0x10000
    s_mul_i32 s59, s49, 6144
    s_add_u32 s50, s50, s59
    v_add_u32 v42, s50, v43
    v_add_u32 v48, 64, v42
    v_add_u32 v50, 128, v42
    ds_read_b64_tr_b16 v[16:17], v42 offset:0
    ds_read_b64_tr_b16 v[18:19], v42 offset:1536
    ds_read_b64_tr_b16 v[20:21], v48 offset:0
    ds_read_b64_tr_b16 v[22:23], v48 offset:1536
    ds_read_b64_tr_b16 v[24:25], v50 offset:0
    ds_read_b64_tr_b16 v[26:27], v50 offset:1536
    ds_read_b64_tr_b16 v[28:29], v42 offset:3072
    ds_read_b64_tr_b16 v[30:31], v42 offset:4608
    ds_read_b64_tr_b16 v[32:33], v48 offset:3072
    ds_read_b64_tr_b16 v[34:35], v48 offset:4608
    ds_read_b64_tr_b16 v[36:37], v50 offset:3072
    ds_read_b64_tr_b16 v[38:39], v50 offset:4608
    s_waitcnt lgkmcnt(10)
    v_mfma_f32_32x32x16_bf16 v[64:79], v[52:55], v[16:19], v[64:79]
    s_waitcnt lgkmcnt(8)
    v_mfma_f32_32x32x16_bf16 v[80:95], v[52:55], v[20:23], v[80:95]
    s_waitcnt lgkmcnt(6)
    v_mfma_f32_32x32x16_bf16 v[96:111], v[52:55], v[24:27], v[96:111]
    s_waitcnt lgkmcnt(4)
    v_mfma_f32_32x32x16_bf16 v[64:79], v[52:55], v[28:31], v[64:79]
    s_waitcnt lgkmcnt(2)
    v_mfma_f32_32x32x16_bf16 v[80:95], v[52:55], v[32:35], v[80:95]
    s_waitcnt lgkmcnt(0)
    v_mfma_f32_32x32x16_bf16 v[96:111], v[52:55], v[36:39], v[96:111]
    s_mov_b32 s50, 0x20800
    s_mul_i32 s59, s49, 6144
    s_add_u32 s50, s50, s59
    v_add_u32 v42, s50, v43
    v_add_u32 v48, 64, v42
    v_add_u32 v50, 128, v42
    ds_read_b64_tr_b16 v[16:17], v42 offset:0
    ds_read_b64_tr_b16 v[18:19], v42 offset:1536
    ds_read_b64_tr_b16 v[20:21], v48 offset:0
    ds_read_b64_tr_b16 v[22:23], v48 offset:1536
    ds_read_b64_tr_b16 v[24:25], v50 offset:0
    ds_read_b64_tr_b16 v[26:27], v50 offset:1536
    ds_read_b64_tr_b16 v[28:29], v42 offset:3072
    ds_read_b64_tr_b16 v[30:31], v42 offset:4608
    ds_read_b64_tr_b16 v[32:33], v48 offset:3072
    ds_read_b64_tr_b16 v[34:35], v48 offset:4608
    ds_read_b64_tr_b16 v[36:37], v50 offset:3072
    ds_read_b64_tr_b16 v[38:39], v50 offset:4608
    s_waitcnt lgkmcnt(10)
    v_mfma_f32_32x32x16_bf16 v[64:79], v[52:55], v[16:19], v[64:79]
    s_waitcnt lgkmcnt(8)
    v_mfma_f32_32x32x16_bf16 v[80:95], v[52:55], v[20:23], v[80:95]
    s_waitcnt lgkmcnt(6)
    v_mfma_f32_32x32x16_bf16 v[96:111], v[52:55], v[24:27], v[96:111]
    s_waitcnt lgkmcnt(4)
    v_mfma_f32_32x32x16_bf16 v[64:79], v[52:55], v[28:31], v[64:79]
    s_waitcnt lgkmcnt(2)
    v_mfma_f32_32x32x16_bf16 v[80:95], v[52:55], v[32:35], v[80:95]
    s_waitcnt lgkmcnt(0)
    v_mfma_f32_32x32x16_bf16 v[96:111], v[52:55], v[36:39], v[96:111]
L_wcs_83:
    s_mov_b32 s50, s53
    s_mov_b32 s51, s54
    s_barrier
    s_mov_b32 s52, 3
L_dl_86:
    s_add_u32 m0, s51, 0
    s_nop 0
    buffer_load_dwordx4 v44, s[8:11], s50 offen lds
    s_add_u32 m0, s51, 1024
    s_nop 0
    buffer_load_dwordx4 v45, s[8:11], s50 offen lds
    s_add_u32 m0, s51, 2048
    s_nop 0
    buffer_load_dwordx4 v46, s[8:11], s50 offen lds
    s_add_u32 s50, s50, 44032
    s_add_u32 s51, s51, 3072
    s_sub_u32 s52, s52, 1
    s_cmp_lg_u32 s52, 0
    s_cbranch_scc1 L_dl_86
    s_barrier
    s_mov_b32 s52, 1
L_dl_87:
    s_add_u32 m0, s51, 0
    s_nop 0
    buffer_load_dwordx4 v44, s[8:11], s50 offen lds
    s_add_u32 m0, s51, 1024
    s_nop 0
    buffer_load_dwordx4 v45, s[8:11], s50 offen lds
    s_add_u32 m0, s51, 2048
    s_nop 0
    buffer_load_dwordx4 v46, s[8:11], s50 offen lds
    s_add_u32 s50, s50, 44032
    s_add_u32 s51, s51, 3072
    s_sub_u32 s52, s52, 1
    s_cmp_lg_u32 s52, 0
    s_cbranch_scc1 L_dl_87
    s_cmp_lg_u32 s49, 3
    s_cbranch_scc1 L_wcs_84
    s_mov_b32 s50, 0x142800
    s_mul_i32 s59, s42, 192
    s_add_u32 s50, s50, s59
    s_mov_b32 s51, 59392
    s_mov_b32 s52, 2
L_dl_88:
    s_add_u32 m0, s51, 0
    s_nop 0
    buffer_load_dwordx4 v44, s[8:11], s50 offen lds
    s_add_u32 m0, s51, 1024
    s_nop 0
    buffer_load_dwordx4 v45, s[8:11], s50 offen lds
    s_add_u32 m0, s51, 2048
    s_nop 0
    buffer_load_dwordx4 v46, s[8:11], s50 offen lds
    s_add_u32 s50, s50, 44032
    s_add_u32 s51, s51, 3072
    s_sub_u32 s52, s52, 1
    s_cmp_lg_u32 s52, 0
    s_cbranch_scc1 L_dl_88
L_wcs_84:
    s_cmp_lg_u32 s36, 0
    s_cbranch_scc1 L_n_done_74
    s_and_b32 s54, s49, 1
    s_mov_b32 s50, 0x16000
    s_mul_i32 s59, s49, 12288
    s_add_u32 s50, s50, s59
    s_add_u32 s53, s50, 6144
    s_cmp_eq_u32 s49, 3
    s_cselect_b32 s53, 59392, s53
    s_waitcnt vmcnt(0)
    v_add_u32 v42, s50, v43
    v_add_u32 v48, 64, v42
    v_add_u32 v50, 128, v42
    ds_read_b64_tr_b16 v[16:17], v42 offset:0
    ds_read_b64_tr_b16 v[18:19], v42 offset:1536
    ds_read_b64_tr_b16 v[20:21], v48 offset:0
    ds_read_b64_tr_b16 v[22:23], v48 offset:1536
    ds_read_b64_tr_b16 v[24:25], v50 offset:0
    ds_read_b64_tr_b16 v[26:27], v50 offset:1536
    ds_read_b64_tr_b16 v[28:29], v42 offset:3072
    ds_read_b64_tr_b16 v[30:31], v42 offset:4608
    ds_read_b64_tr_b16 v[32:33], v48 offset:3072
    ds_read_b64_tr_b16 v[34:35], v48 offset:4608
    ds_read_b64_tr_b16 v[36:37], v50 offset:3072
    ds_read_b64_tr_b16 v[38:39], v50 offset:4608
    s_waitcnt lgkmcnt(10)
    v_mfma_f32_32x32x16_bf16 v[64:79], v[52:55], v[16:19], v[64:79]
    s_waitcnt lgkmcnt(8)
    v_mfma_f32_32x32x16_bf16 v[80:95], v[52:55], v[20:23], v[80:95]
    s_waitcnt lgkmcnt(6)
    v_mfma_f32_32x32x16_bf16 v[96:111], v[52:55], v[24:27], v[96:111]
    s_waitcnt lgkmcnt(4)
    v_mfma_f32_32x32x16_bf16 v[64:79], v[52:55], v[28:31], v[64:79]
    s_waitcnt lgkmcnt(2)
    v_mfma_f32_32x32x16_bf16 v[80:95], v[52:55], v[32:35], v[80:95]
    s_waitcnt lgkmcnt(0)
    v_mfma_f32_32x32x16_bf16 v[96:111], v[52:55], v[36:39], v[96:111]
    s_mov_b32 s50, s53
    v_add_u32 v42, s50, v43
    v_add_u32 v48, 64, v42
    v_add_u32 v50, 128, v42
    ds_read_b64_tr_b16 v[16:17], v42 offset:0
    ds_read_b64_tr_b16 v[18:19], v42 offset:1536
    ds_read_b64_tr_b16 v[20:21], v48 offset:0
    ds_read_b64_tr_b16 v[22:23], v48 offset:1536
    ds_read_b64_tr_b16 v[24:25], v50 offset:0
    ds_read_b64_tr_b16 v[26:27], v50 offset:1536
    ds_read_b64_tr_b16 v[28:29], v42 offset:3072
    ds_read_b64_tr_b16 v[30:31], v42 offset:4608
    ds_read_b64_tr_b16 v[32:33], v48 offset:3072
    ds_read_b64_tr_b16 v[34:35], v48 offset:4608
    ds_read_b64_tr_b16 v[36:37], v50 offset:3072
    ds_read_b64_tr_b16 v[38:39], v50 offset:4608
    s_waitcnt lgkmcnt(10)
    v_mfma_f32_32x32x16_bf16 v[64:79], v[52:55], v[16:19], v[64:79]
    s_waitcnt lgkmcnt(8)
    v_mfma_f32_32x32x16_bf16 v[80:95], v[52:55], v[20:23], v[80:95]
    s_waitcnt lgkmcnt(6)
    v_mfma_f32_32x32x16_bf16 v[96:111], v[52:55], v[24:27], v[96:111]
    s_waitcnt lgkmcnt(4)
    v_mfma_f32_32x32x16_bf16 v[64:79], v[52:55], v[28:31], v[64:79]
    s_waitcnt lgkmcnt(2)
    v_mfma_f32_32x32x16_bf16 v[80:95], v[52:55], v[32:35], v[80:95]
    s_waitcnt lgkmcnt(0)
    v_mfma_f32_32x32x16_bf16 v[96:111], v[52:55], v[36:39], v[96:111]
    v_and_b32 v41, 31, v0
    v_lshlrev_b32 v41, 2, v41
    s_mov_b32 s50, 0x27a00
    s_mul_i32 s59, s49, 384
    s_add_u32 s50, s50, s59
    v_add_u32 v42, s50, v41
    s_nop 7
    ds_write_b32 v42, v64 offset:0
    ds_write_b32 v42, v80 offset:128
    ds_write_b32 v42, v96 offset:256
    v_lshlrev_b32 v47, 16, v224
    s_mov_b32 s50, 0x27400
    s_mul_i32 s59, s49, 128
    s_add_u32 s50, s50, s59
    v_add_u32 v42, s50, v41
    ds_write_b32 v42, v47
    v_lshlrev_b32 v49, 16, v225
    s_mov_b32 s50, 0x27180
    s_mul_i32 s59, s54, 512
    s_add_u32 s50, s50, s59
    v_add_u32 v42, s50, v41
    ds_write_b32 v42, v49
L_n_done_74:
    s_cmp_ge_u32 s34, 4
    s_cbranch_scc1 L_f1_h_89
    s_cmp_eq_u32 s42, 15
    s_cbranch_scc1 L_f1_idle_91
    ds_read_b64_tr_b16 v[192:193], v244 offset:0
    ds_read_b64_tr_b16 v[194:195], v244 offset:1536
    ds_read_b64_tr_b16 v[196:197], v244 offset:64
    ds_read_b64_tr_b16 v[198:199], v244 offset:1600
    ds_read_b64_tr_b16 v[200:201], v244 offset:128
    ds_read_b64_tr_b16 v[202:203], v244 offset:1664
    ds_read_b64_tr_b16 v[204:205], v244 offset:3072
    ds_read_b64_tr_b16 v[206:207], v244 offset:4608
    ds_read_b64_tr_b16 v[208:209], v244 offset:3136
    ds_read_b64_tr_b16 v[210:211], v244 offset:4672
    ds_read_b64_tr_b16 v[212:213], v244 offset:3200
    ds_read_b64_tr_b16 v[214:215], v244 offset:4736
    s_mov_b32 s60, 65536
    buffer_load_dwordx2 v[6:7], v4, s[4:7], s50 offen sc1
L_poll_93:
    buffer_load_dwordx2 v[16:17], v4, s[4:7], s50 offen sc1
    s_waitcnt vmcnt(1)
    v_cmp_eq_u64 vcc, v[6:7], v[2:3]
    s_nop 0
    s_cmp_eq_u64 vcc, -1
    s_cbranch_scc1 L_pok_94
    buffer_load_dwordx2 v[6:7], v4, s[4:7], s50 offen sc1
    s_waitcnt vmcnt(1)
    v_cmp_eq_u64 vcc, v[16:17], v[2:3]
    s_nop 0
    s_cmp_eq_u64 vcc, -1
    s_cbranch_scc1 L_pok_94
    s_sub_u32 s60, s60, 1
    s_cbranch_scc0 L_poll_93
    s_endpgm
L_pok_94:
    s_add_u32 s58, s51, 0
    buffer_load_dwordx4 v[16:19], v1, s[4:7], s58 offen offset:0 sc1
    buffer_load_dwordx4 v[20:23], v1, s[4:7], s58 offen offset:1024 sc1
    buffer_load_dwordx4 v[24:27], v1, s[4:7], s58 offen offset:2048 sc1
    buffer_load_dwordx4 v[28:31], v1, s[4:7], s58 offen offset:3072 sc1
    s_add_u32 s58, s51, 4096
    buffer_load_dwordx4 v[32:35], v1, s[4:7], s58 offen offset:0 sc1
    buffer_load_dwordx4 v[36:39], v1, s[4:7], s58 offen offset:1024 sc1
    buffer_load_dwordx4 v[40:43], v1, s[4:7], s58 offen offset:2048 sc1
    buffer_load_dwordx4 v[44:47], v1, s[4:7], s58 offen offset:3072 sc1
    s_add_u32 s58, s51, 8192
    buffer_load_dwordx4 v[48:51], v1, s[4:7], s58 offen offset:0 sc1
    buffer_load_dwordx4 v[52:55], v1, s[4:7], s58 offen offset:1024 sc1
    s_waitcnt vmcnt(9) lgkmcnt(6)
    v_mfma_f32_32x32x16_bf16 v[144:159], v[192:195], v[16:19], 0
    ds_read_b64_tr_b16 v[216:217], v244 offset:6144
    ds_read_b64_tr_b16 v[218:219], v244 offset:7680
    buffer_load_dwordx4 v[56:59], v1, s[4:7], s58 offen offset:2048 sc1
    v_mfma_f32_32x32x16_bf16 v[160:175], v[196:199], v[16:19], 0
    ds_read_b64_tr_b16 v[220:221], v244 offset:6208
    ds_read_b64_tr_b16 v[222:223], v244 offset:7744
    v_mfma_f32_32x32x16_bf16 v[176:191], v[200:203], v[16:19], 0
    ds_read_b64_tr_b16 v[224:225], v244 offset:6272
    ds_read_b64_tr_b16 v[226:227], v244 offset:7808
    s_waitcnt vmcnt(9) lgkmcnt(6)
    v_mfma_f32_32x32x16_bf16 v[144:159], v[204:207], v[20:23], v[144:159]
    ds_read_b64_tr_b16 v[192:193], v244 offset:9216
    ds_read_b64_tr_b16 v[194:195], v244 offset:10752
    buffer_load_dwordx4 v[60:63], v1, s[4:7], s58 offen offset:3072 sc1
    v_mfma_f32_32x32x16_bf16 v[160:175], v[208:211], v[20:23], v[160:175]
    ds_read_b64_tr_b16 v[196:197], v244 offset:9280
    ds_read_b64_tr_b16 v[198:199], v244 offset:10816
    buffer_load_dwordx4 v[228:231], v1, s[4:7], s52 offen offset:0 sc1
    v_mfma_f32_32x32x16_bf16 v[176:191], v[212:215], v[20:23], v[176:191]
    ds_read_b64_tr_b16 v[200:201], v244 offset:9344
    ds_read_b64_tr_b16 v[202:203], v244 offset:10880
    s_waitcnt vmcnt(10) lgkmcnt(6)
    v_mfma_f32_32x32x16_bf16 v[144:159], v[216:219], v[24:27], v[144:159]
    ds_read_b64_tr_b16 v[204:205], v244 offset:12288
    ds_read_b64_tr_b16 v[206:207], v244 offset:13824
    s_add_u32 s58, s51, 12288
    buffer_load_dwordx4 v[64:67], v1, s[4:7], s58 offen offset:0 sc1
    v_mfma_f32_32x32x16_bf16 v[160:175], v[220:223], v[24:27], v[160:175]
    ds_read_b64_tr_b16 v[208:209], v244 offset:12352
    ds_read_b64_tr_b16 v[210:211], v244 offset:13888
    buffer_load_dwordx4 v[232:235], v1, s[4:7], s52 offen offset:1024 sc1
    v_mfma_f32_32x32x16_bf16 v[176:191], v[224:227], v[24:27], v[176:191]
    ds_read_b64_tr_b16 v[212:213], v244 offset:12416
    ds_read_b64_tr_b16 v[214:215], v244 offset:13952
    s_waitcnt vmcnt(11) lgkmcnt(6)
    v_mfma_f32_32x32x16_bf16 v[144:159], v[192:195], v[28:31], v[144:159]
    ds_read_b64_tr_b16 v[216:217], v244 offset:15360
    ds_read_b64_tr_b16 v[218:219], v244 offset:16896
    buffer_load_dwordx4 v[68:71], v1, s[4:7], s58 offen offset:1024 sc1
    v_mfma_f32_32x32x16_bf16 v[160:175], v[196:199], v[28:31], v[160:175]
    ds_read_b64_tr_b16 v[220:221], v244 offset:15424
    ds_read_b64_tr_b16 v[222:223], v244 offset:16960
    buffer_load_dwordx4 v[236:239], v1, s[4:7], s52 offen offset:2048 sc1
    v_mfma_f32_32x32x16_bf16 v[176:191], v[200:203], v[28:31], v[176:191]
    ds_read_b64_tr_b16 v[224:225], v244 offset:15488
    ds_read_b64_tr_b16 v[226:227], v244 offset:17024
    s_waitcnt vmcnt(12) lgkmcnt(6)
    v_mfma_f32_32x32x16_bf16 v[144:159], v[204:207], v[32:35], v[144:159]
    ds_read_b64_tr_b16 v[192:193], v244 offset:18432
    ds_read_b64_tr_b16 v[194:195], v244 offset:19968
    buffer_load_dwordx4 v[72:75], v1, s[4:7], s58 offen offset:2048 sc1
    v_mfma_f32_32x32x16_bf16 v[160:175], v[208:211], v[32:35], v[160:175]
    ds_read_b64_tr_b16 v[196:197], v244 offset:18496
    ds_read_b64_tr_b16 v[198:199], v244 offset:20032
    buffer_load_dwordx4 v[240:243], v1, s[4:7], s52 offen offset:3072 sc1
    v_mfma_f32_32x32x16_bf16 v[176:191], v[212:215], v[32:35], v[176:191]
    ds_read_b64_tr_b16 v[200:201], v244 offset:18560
    ds_read_b64_tr_b16 v[202:203], v244 offset:20096
    s_waitcnt vmcnt(13) lgkmcnt(6)
    v_mfma_f32_32x32x16_bf16 v[144:159], v[216:219], v[36:39], v[144:159]
    ds_read_b64_tr_b16 v[204:205], v244 offset:21504
    ds_read_b64_tr_b16 v[206:207], v244 offset:23040
    buffer_load_dwordx4 v[76:79], v1, s[4:7], s58 offen offset:3072 sc1
    s_add_u32 s54, s37, 0x90000
    s_mul_i32 s59, s41, 99328
    v_mfma_f32_32x32x16_bf16 v[160:175], v[220:223], v[36:39], v[160:175]
    ds_read_b64_tr_b16 v[208:209], v244 offset:21568
    ds_read_b64_tr_b16 v[210:211], v244 offset:23104
    s_add_u32 s54, s54, s59
    s_mul_i32 s59, s42, 6144
    v_mfma_f32_32x32x16_bf16 v[176:191], v[224:227], v[36:39], v[176:191]
    ds_read_b64_tr_b16 v[212:213], v244 offset:21632
    ds_read_b64_tr_b16 v[214:215], v244 offset:23168
    s_add_u32 s54, s54, s59
    s_add_u32 s55, s54, 4096
    s_barrier
    s_waitcnt vmcnt(13) lgkmcnt(6)
    v_mfma_f32_32x32x16_bf16 v[144:159], v[192:195], v[40:43], v[144:159]
    ds_read_b64_tr_b16 v[216:217], v244 offset:24576
    ds_read_b64_tr_b16 v[218:219], v244 offset:26112
    s_add_u32 s58, s51, 16384
    buffer_load_dwordx4 v[80:83], v1, s[4:7], s58 offen offset:0 sc1
    s_add_u32 s56, s38, 5120
    s_mul_i32 s59, s41, 128
    v_mfma_f32_32x32x16_bf16 v[160:175], v[196:199], v[40:43], v[160:175]
    ds_read_b64_tr_b16 v[220:221], v244 offset:24640
    ds_read_b64_tr_b16 v[222:223], v244 offset:26176
    s_add_u32 s56, s56, s59
    s_mul_i32 s59, s42, 8
    v_mfma_f32_32x32x16_bf16 v[176:191], v[200:203], v[40:43], v[176:191]
    ds_read_b64_tr_b16 v[224:225], v244 offset:24704
    ds_read_b64_tr_b16 v[226:227], v244 offset:26240
    s_add_u32 s56, s56, s59
    s_waitcnt vmcnt(13) lgkmcnt(6)
    v_mfma_f32_32x32x16_bf16 v[144:159], v[204:207], v[44:47], v[144:159]
    ds_read_b64_tr_b16 v[192:193], v244 offset:27648
    ds_read_b64_tr_b16 v[194:195], v244 offset:29184
    buffer_load_dwordx4 v[84:87], v1, s[4:7], s58 offen offset:1024 sc1
    v_mfma_f32_32x32x16_bf16 v[160:175], v[208:211], v[44:47], v[160:175]
    ds_read_b64_tr_b16 v[196:197], v244 offset:27712
    ds_read_b64_tr_b16 v[198:199], v244 offset:29248
    v_mfma_f32_32x32x16_bf16 v[176:191], v[212:215], v[44:47], v[176:191]
    ds_read_b64_tr_b16 v[200:201], v244 offset:27776
    ds_read_b64_tr_b16 v[202:203], v244 offset:29312
    s_waitcnt vmcnt(13) lgkmcnt(6)
    v_mfma_f32_32x32x16_bf16 v[144:159], v[216:219], v[48:51], v[144:159]
    ds_read_b64_tr_b16 v[204:205], v244 offset:30720
    ds_read_b64_tr_b16 v[206:207], v244 offset:32256
    buffer_load_dwordx4 v[88:91], v1, s[4:7], s58 offen offset:2048 sc1
    v_mfma_f32_32x32x16_bf16 v[160:175], v[220:223], v[48:51], v[160:175]
    ds_read_b64_tr_b16 v[208:209], v244 offset:30784
    ds_read_b64_tr_b16 v[210:211], v244 offset:32320
    v_mfma_f32_32x32x16_bf16 v[176:191], v[224:227], v[48:51], v[176:191]
    ds_read_b64_tr_b16 v[212:213], v244 offset:30848
    ds_read_b64_tr_b16 v[214:215], v244 offset:32384
    s_waitcnt vmcnt(13) lgkmcnt(6)
    v_mfma_f32_32x32x16_bf16 v[144:159], v[192:195], v[52:55], v[144:159]
    ds_read_b64_tr_b16 v[216:217], v244 offset:33792
    ds_read_b64_tr_b16 v[218:219], v244 offset:35328
    buffer_load_dwordx4 v[92:95], v1, s[4:7], s58 offen offset:3072 sc1
    v_mfma_f32_32x32x16_bf16 v[160:175], v[196:199], v[52:55], v[160:175]
    ds_read_b64_tr_b16 v[220:221], v244 offset:33856
    ds_read_b64_tr_b16 v[222:223], v244 offset:35392
    v_mfma_f32_32x32x16_bf16 v[176:191], v[200:203], v[52:55], v[176:191]
    ds_read_b64_tr_b16 v[224:225], v244 offset:33920
    ds_read_b64_tr_b16 v[226:227], v244 offset:35456
    s_waitcnt vmcnt(13) lgkmcnt(6)
    v_mfma_f32_32x32x16_bf16 v[144:159], v[204:207], v[56:59], v[144:159]
    ds_read_b64_tr_b16 v[192:193], v244 offset:36864
    ds_read_b64_tr_b16 v[194:195], v244 offset:38400
    s_add_u32 s58, s51, 20480
    buffer_load_dwordx4 v[96:99], v1, s[4:7], s58 offen offset:0 sc1
    v_mfma_f32_32x32x16_bf16 v[160:175], v[208:211], v[56:59], v[160:175]
    ds_read_b64_tr_b16 v[196:197], v244 offset:36928
    ds_read_b64_tr_b16 v[198:199], v244 offset:38464
    v_mfma_f32_32x32x16_bf16 v[176:191], v[212:215], v[56:59], v[176:191]
    ds_read_b64_tr_b16 v[200:201], v244 offset:36992
    ds_read_b64_tr_b16 v[202:203], v244 offset:38528
    s_waitcnt vmcnt(6) lgkmcnt(6)
    v_mfma_f32_32x32x16_bf16 v[144:159], v[216:219], v[60:63], v[144:159]
    ds_read_b64_tr_b16 v[204:205], v244 offset:39936
    ds_read_b64_tr_b16 v[206:207], v244 offset:41472
    buffer_load_dwordx4 v[100:103], v1, s[4:7], s58 offen offset:1024 sc1
    v_add_f32 v228, v228, v229
    v_add_f32 v228, v228, v230
    v_mfma_f32_32x32x16_bf16 v[160:175], v[220:223], v[60:63], v[160:175]
    ds_read_b64_tr_b16 v[208:209], v244 offset:40000
    ds_read_b64_tr_b16 v[210:211], v244 offset:41536
    v_add_f32 v228, v228, v231
    v_add_f32 v228, v228, v232
    v_mfma_f32_32x32x16_bf16 v[176:191], v[224:227], v[60:63], v[176:191]
    ds_read_b64_tr_b16 v[212:213], v244 offset:40064
    ds_read_b64_tr_b16 v[214:215], v244 offset:41600
    v_add_f32 v228, v228, v233
    v_add_f32 v228, v228, v234
    s_barrier
    s_waitcnt vmcnt(7) lgkmcnt(6)
    v_mfma_f32_32x32x16_bf16 v[144:159], v[192:195], v[64:67], v[144:159]
    ds_read_b64_tr_b16 v[216:217], v244 offset:43008
    ds_read_b64_tr_b16 v[218:219], v244 offset:44544
    buffer_load_dwordx4 v[104:107], v1, s[4:7], s58 offen offset:2048 sc1
    v_add_f32 v228, v228, v235
    v_add_f32 v228, v228, v236
    v_mfma_f32_32x32x16_bf16 v[160:175], v[196:199], v[64:67], v[160:175]
    ds_read_b64_tr_b16 v[220:221], v244 offset:43072
    ds_read_b64_tr_b16 v[222:223], v244 offset:44608
    v_add_f32 v228, v228, v237
    v_add_f32 v228, v228, v238
    v_mfma_f32_32x32x16_bf16 v[176:191], v[200:203], v[64:67], v[176:191]
    ds_read_b64_tr_b16 v[224:225], v244 offset:43136
    ds_read_b64_tr_b16 v[226:227], v244 offset:44672
    v_add_f32 v228, v228, v239
    v_add_f32 v228, v228, v240
    s_waitcnt vmcnt(8) lgkmcnt(6)
    v_mfma_f32_32x32x16_bf16 v[144:159], v[204:207], v[68:71], v[144:159]
    ds_read_b64_tr_b16 v[192:193], v244 offset:46080
    ds_read_b64_tr_b16 v[194:195], v244 offset:47616
    buffer_load_dwordx4 v[108:111], v1, s[4:7], s58 offen offset:3072 sc1
    v_add_f32 v228, v228, v241
    v_add_f32 v228, v228, v242
    v_mfma_f32_32x32x16_bf16 v[160:175], v[208:211], v[68:71], v[160:175]
    ds_read_b64_tr_b16 v[196:197], v244 offset:46144
    ds_read_b64_tr_b16 v[198:199], v244 offset:47680
    v_add_f32 v228, v228, v243
    v_mov_b32 v229, v228
    v_mfma_f32_32x32x16_bf16 v[176:191], v[212:215], v[68:71], v[176:191]
    ds_read_b64_tr_b16 v[200:201], v244 offset:46208
    ds_read_b64_tr_b16 v[202:203], v244 offset:47744
    s_nop 1
    v_permlane32_swap_b32 v228, v229
    s_waitcnt vmcnt(9) lgkmcnt(6)
    v_mfma_f32_32x32x16_bf16 v[144:159], v[216:219], v[72:75], v[144:159]
    ds_read_b64_tr_b16 v[204:205], v244 offset:49152
    ds_read_b64_tr_b16 v[206:207], v244 offset:50688
    s_add_u32 s58, s51, 24576
    buffer_load_dwordx4 v[112:115], v1, s[4:7], s58 offen offset:0 sc1
    s_nop 1
    v_mul_f32 v246, 0x3b000000, v228
    v_mfma_f32_32x32x16_bf16 v[160:175], v[220:223], v[72:75], v[160:175]
    ds_read_b64_tr_b16 v[208:209], v244 offset:49216
    ds_read_b64_tr_b16 v[210:211], v244 offset:50752
    v_mul_f32 v229, 0x3b000000, v229
    v_fma_f32 v229, -v246, v246, v229
    v_mfma_f32_32x32x16_bf16 v[176:191], v[224:227], v[72:75], v[176:191]
    ds_read_b64_tr_b16 v[212:213], v244 offset:49280
    ds_read_b64_tr_b16 v[214:215], v244 offset:50816
    v_max_f32 v229, 0, v229
    v_add_f32 v230, 0x3727c5ac, v229
    s_waitcnt vmcnt(9) lgkmcnt(6)
    v_mfma_f32_32x32x16_bf16 v[144:159], v[192:195], v[76:79], v[144:159]
    ds_read_b64_tr_b16 v[216:217], v244 offset:52224
    ds_read_b64_tr_b16 v[218:219], v244 offset:53760
    buffer_load_dwordx4 v[116:119], v1, s[4:7], s58 offen offset:1024 sc1
    v_rsq_f32 v248, v230
    s_nop 0
    v_mfma_f32_32x32x16_bf16 v[160:175], v[196:199], v[76:79], v[160:175]
    ds_read_b64_tr_b16 v[220:221], v244 offset:52288
    ds_read_b64_tr_b16 v[222:223], v244 offset:53824
    v_mul_f32 v230, v248, v248
    v_mul_f32 v230, v230, v229
    v_mfma_f32_32x32x16_bf16 v[176:191], v[200:203], v[76:79], v[176:191]
    ds_read_b64_tr_b16 v[224:225], v244 offset:52352
    ds_read_b64_tr_b16 v[226:227], v244 offset:53888
    v_add_f32 v230, 0x3727c5ac, v230
    v_rsq_f32 v230, v230
    s_waitcnt vmcnt(9) lgkmcnt(6)
    v_mfma_f32_32x32x16_bf16 v[144:159], v[204:207], v[80:83], v[144:159]
    ds_read_b64_tr_b16 v[192:193], v244 offset:55296
    ds_read_b64_tr_b16 v[194:195], v244 offset:56832
    buffer_load_dwordx4 v[120:123], v1, s[4:7], s58 offen offset:2048 sc1
    s_nop 0
    v_mul_f32 v248, v248, v230
    v_mfma_f32_32x32x16_bf16 v[160:175], v[208:211], v[80:83], v[160:175]
    ds_read_b64_tr_b16 v[196:197], v244 offset:55360
    ds_read_b64_tr_b16 v[198:199], v244 offset:56896
    v_mul_f32 v246, v246, v248
    v_mov_b32 v232, 0xc0135761
    v_mfma_f32_32x32x16_bf16 v[176:191], v[212:215], v[80:83], v[176:191]
    ds_read_b64_tr_b16 v[200:201], v244 offset:55424
    ds_read_b64_tr_b16 v[202:203], v244 offset:56960
    v_mov_b32 v233, 0xbdd2d3e8
    v_mov_b32 v234, 1.0
    s_waitcnt vmcnt(9) lgkmcnt(6)
    v_mfma_f32_32x32x16_bf16 v[144:159], v[216:219], v[84:87], v[144:159]
    ds_read_b64_tr_b16 v[204:205], v244 offset:58368
    ds_read_b64_tr_b16 v[206:207], v244 offset:59904
    buffer_load_dwordx4 v[124:127], v1, s[4:7], s58 offen offset:3072 sc1
    ds_read_b128 v[16:19], v251 offset:512
    ds_read_b128 v[20:23], v251 offset:544
    v_mfma_f32_32x32x16_bf16 v[160:175], v[220:223], v[84:87], v[160:175]
    ds_read_b64_tr_b16 v[208:209], v244 offset:58432
    ds_read_b64_tr_b16 v[210:211], v244 offset:59968
    ds_read_b128 v[24:27], v251 offset:576
    ds_read_b128 v[28:31], v251 offset:608
    v_mfma_f32_32x32x16_bf16 v[176:191], v[224:227], v[84:87], v[176:191]
    ds_read_b64_tr_b16 v[212:213], v244 offset:58496
    ds_read_b64_tr_b16 v[214:215], v244 offset:60032
    ds_read_b128 v[32:35], v251 offset:1024
    ds_read_b128 v[36:39], v251 offset:1056
    s_waitcnt vmcnt(9) lgkmcnt(12)
    v_mfma_f32_32x32x16_bf16 v[144:159], v[192:195], v[88:91], v[144:159]
    ds_read_b64_tr_b16 v[216:217], v244 offset:61440
    ds_read_b64_tr_b16 v[218:219], v244 offset:62976
    s_add_u32 s58, s51, 28672
    buffer_load_dwordx4 v[128:131], v1, s[4:7], s58 offen offset:0 sc1
    ds_read_b128 v[40:43], v251 offset:1088
    ds_read_b128 v[44:47], v251 offset:1120
    v_mfma_f32_32x32x16_bf16 v[160:175], v[196:199], v[88:91], v[160:175]
    ds_read_b64_tr_b16 v[220:221], v244 offset:61504
    ds_read_b64_tr_b16 v[222:223], v244 offset:63040
    s_waitcnt lgkmcnt(2)
    v_fma_f32 v32, -v246, v16, v32
    v_mfma_f32_32x32x16_bf16 v[176:191], v[200:203], v[88:91], v[176:191]
    ds_read_b64_tr_b16 v[224:225], v244 offset:61568
    ds_read_b64_tr_b16 v[226:227], v244 offset:63104
    ds_read_b128 v[48:51], v251 offset:640
    v_fma_f32 v33, -v246, v17, v33
    s_waitcnt vmcnt(9)
    v_mfma_f32_32x32x16_bf16 v[144:159], v[204:207], v[92:95], v[144:159]
    ds_read_b64_tr_b16 v[192:193], v245 offset:0
    ds_read_b64_tr_b16 v[194:195], v245 offset:1536
    buffer_load_dwordx4 v[132:135], v1, s[4:7], s58 offen offset:1024 sc1
    v_fma_f32 v34, -v246, v18, v34
    ds_read_b128 v[52:55], v251 offset:672
    v_mfma_f32_32x32x16_bf16 v[160:175], v[208:211], v[92:95], v[160:175]
    ds_read_b64_tr_b16 v[196:197], v245 offset:64
    ds_read_b64_tr_b16 v[198:199], v245 offset:1600
    v_fma_f32 v35, -v246, v19, v35
    v_fma_f32 v36, -v246, v20, v36
    v_mfma_f32_32x32x16_bf16 v[176:191], v[212:215], v[92:95], v[176:191]
    ds_read_b64_tr_b16 v[200:201], v245 offset:128
    ds_read_b64_tr_b16 v[202:203], v245 offset:1664
    ds_read_b128 v[56:59], v251 offset:704
    v_fma_f32 v37, -v246, v21, v37
    s_waitcnt vmcnt(9) lgkmcnt(9)
    v_mfma_f32_32x32x16_bf16 v[144:159], v[216:219], v[96:99], v[144:159]
    ds_read_b64_tr_b16 v[204:205], v245 offset:3072
    ds_read_b64_tr_b16 v[206:207], v245 offset:4608
    buffer_load_dwordx4 v[136:139], v1, s[4:7], s58 offen offset:2048 sc1
    v_fma_f32 v38, -v246, v22, v38
    ds_read_b128 v[60:63], v251 offset:736
    v_mfma_f32_32x32x16_bf16 v[160:175], v[220:223], v[96:99], v[160:175]
    ds_read_b64_tr_b16 v[208:209], v245 offset:3136
    ds_read_b64_tr_b16 v[210:211], v245 offset:4672
    v_fma_f32 v39, -v246, v23, v39
    v_fma_f32 v40, -v246, v24, v40
    v_mfma_f32_32x32x16_bf16 v[176:191], v[224:227], v[96:99], v[176:191]
    ds_read_b64_tr_b16 v[212:213], v245 offset:3200
    ds_read_b64_tr_b16 v[214:215], v245 offset:4736
    ds_read_b128 v[64:67], v251 offset:1152
    v_fma_f32 v41, -v246, v25, v41
    s_waitcnt vmcnt(9) lgkmcnt(9)
    v_mfma_f32_32x32x16_bf16 v[144:159], v[192:195], v[100:103], v[144:159]
    ds_read_b64_tr_b16 v[216:217], v245 offset:6144
    ds_read_b64_tr_b16 v[218:219], v245 offset:7680
    buffer_load_dwordx4 v[140:143], v1, s[4:7], s58 offen offset:3072 sc1
    v_fma_f32 v42, -v246, v26, v42
    ds_read_b128 v[68:71], v251 offset:1184
    v_mfma_f32_32x32x16_bf16 v[160:175], v[196:199], v[100:103], v[160:175]
    ds_read_b64_tr_b16 v[220:221], v245 offset:6208
    ds_read_b64_tr_b16 v[222:223], v245 offset:7744
    v_fma_f32 v43, -v246, v27, v43
    v_fma_f32 v44, -v246, v28, v44
    v_mfma_f32_32x32x16_bf16 v[176:191], v[200:203], v[100:103], v[176:191]
    ds_read_b64_tr_b16 v[224:225], v245 offset:6272
    ds_read_b64_tr_b16 v[226:227], v245 offset:7808
    ds_read_b128 v[72:75], v251 offset:1216
    v_fma_f32 v45, -v246, v29, v45
    s_barrier
    s_waitcnt vmcnt(9) lgkmcnt(9)
    v_mfma_f32_32x32x16_bf16 v[144:159], v[204:207], v[104:107], v[144:159]
    ds_read_b64_tr_b16 v[192:193], v245 offset:9216
    ds_read_b64_tr_b16 v[194:195], v245 offset:10752
    v_fma_f32 v46, -v246, v30, v46
    ds_read_b128 v[76:79], v251 offset:1248
    v_mfma_f32_32x32x16_bf16 v[160:175], v[208:211], v[104:107], v[160:175]
    ds_read_b64_tr_b16 v[196:197], v245 offset:9280
    ds_read_b64_tr_b16 v[198:199], v245 offset:10816
    v_fma_f32 v47, -v246, v31, v47
    s_waitcnt lgkmcnt(2)
    v_mfma_f32_32x32x16_bf16 v[176:191], v[212:215], v[104:107], v[176:191]
    ds_read_b64_tr_b16 v[200:201], v245 offset:9344
    ds_read_b64_tr_b16 v[202:203], v245 offset:10880
    v_fma_f32 v64, -v246, v48, v64
    v_fma_f32 v65, -v246, v49, v65
    s_waitcnt vmcnt(8)
    v_mfma_f32_32x32x16_bf16 v[144:159], v[216:219], v[108:111], v[144:159]
    ds_read_b64_tr_b16 v[204:205], v245 offset:12288
    ds_read_b64_tr_b16 v[206:207], v245 offset:13824
    v_fma_f32 v66, -v246, v50, v66
    v_fma_f32 v67, -v246, v51, v67
    v_mfma_f32_32x32x16_bf16 v[160:175], v[220:223], v[108:111], v[160:175]
    ds_read_b64_tr_b16 v[208:209], v245 offset:12352
    ds_read_b64_tr_b16 v[210:211], v245 offset:13888
    v_fma_f32 v68, -v246, v52, v68
    v_fma_f32 v69, -v246, v53, v69
    v_mfma_f32_32x32x16_bf16 v[176:191], v[224:227], v[108:111], v[176:191]
    ds_read_b64_tr_b16 v[212:213], v245 offset:12416
    ds_read_b64_tr_b16 v[214:215], v245 offset:13952
    v_fma_f32 v70, -v246, v54, v70
    v_fma_f32 v71, -v246, v55, v71
    s_waitcnt vmcnt(7) lgkmcnt(6)
    v_mfma_f32_32x32x16_bf16 v[144:159], v[192:195], v[112:115], v[144:159]
    ds_read_b64_tr_b16 v[216:217], v245 offset:15360
    ds_read_b64_tr_b16 v[218:219], v245 offset:16896
    v_fma_f32 v72, -v246, v56, v72
    v_fma_f32 v73, -v246, v57, v73
    v_mfma_f32_32x32x16_bf16 v[160:175], v[196:199], v[112:115], v[160:175]
    ds_read_b64_tr_b16 v[220:221], v245 offset:15424
    ds_read_b64_tr_b16 v[222:223], v245 offset:16960
    ds_read_b128 v[80:83], v251 offset:768
    v_fma_f32 v74, -v246, v58, v74
    v_mfma_f32_32x32x16_bf16 v[176:191], v[200:203], v[112:115], v[176:191]
    ds_read_b64_tr_b16 v[224:225], v245 offset:15488
    ds_read_b64_tr_b16 v[226:227], v245 offset:17024
    v_fma_f32 v75, -v246, v59, v75
    ds_read_b128 v[84:87], v251 offset:800
    s_waitcnt vmcnt(6) lgkmcnt(8)
    v_mfma_f32_32x32x16_bf16 v[144:159], v[204:207], v[116:119], v[144:159]
    ds_read_b64_tr_b16 v[192:193], v245 offset:18432
    ds_read_b64_tr_b16 v[194:195], v245 offset:19968
    v_fma_f32 v76, -v246, v60, v76
    v_fma_f32 v77, -v246, v61, v77
    v_mfma_f32_32x32x16_bf16 v[160:175], v[208:211], v[116:119], v[160:175]
    ds_read_b64_tr_b16 v[196:197], v245 offset:18496
    ds_read_b64_tr_b16 v[198:199], v245 offset:20032
    ds_read_b128 v[88:91], v251 offset:832
    v_fma_f32 v78, -v246, v62, v78
    v_mfma_f32_32x32x16_bf16 v[176:191], v[212:215], v[116:119], v[176:191]
    ds_read_b64_tr_b16 v[200:201], v245 offset:18560
    ds_read_b64_tr_b16 v[202:203], v245 offset:20096
    v_fma_f32 v79, -v246, v63, v79
    ds_read_b128 v[92:95], v251 offset:864
    s_waitcnt vmcnt(5) lgkmcnt(9)
    v_mfma_f32_32x32x16_bf16 v[144:159], v[216:219], v[120:123], v[144:159]
    ds_read_b64_tr_b16 v[204:205], v245 offset:21504
    ds_read_b64_tr_b16 v[206:207], v245 offset:23040
    ds_read_b128 v[96:99], v251 offset:1280
    ds_read_b128 v[100:103], v251 offset:1312
    v_mfma_f32_32x32x16_bf16 v[160:175], v[220:223], v[120:123], v[160:175]
    ds_read_b64_tr_b16 v[208:209], v245 offset:21568
    ds_read_b64_tr_b16 v[210:211], v245 offset:23104
    ds_read_b128 v[104:107], v251 offset:1344
    ds_read_b128 v[108:111], v251 offset:1376
    v_mfma_f32_32x32x16_bf16 v[176:191], v[224:227], v[120:123], v[176:191]
    ds_read_b64_tr_b16 v[212:213], v245 offset:21632
    ds_read_b64_tr_b16 v[214:215], v245 offset:23168
    s_waitcnt lgkmcnt(2)
    v_fma_f32 v96, -v246, v80, v96
    s_waitcnt vmcnt(4)
    v_mfma_f32_32x32x16_bf16 v[144:159], v[192:195], v[124:127], v[144:159]
    ds_read_b64_tr_b16 v[216:217], v245 offset:24576
    ds_read_b64_tr_b16 v[218:219], v245 offset:26112
    v_fma_f32 v97, -v246, v81, v97
    v_fma_f32 v98, -v246, v82, v98
    v_mfma_f32_32x32x16_bf16 v[160:175], v[196:199], v[124:127], v[160:175]
    ds_read_b64_tr_b16 v[220:221], v245 offset:24640
    ds_read_b64_tr_b16 v[222:223], v245 offset:26176
    v_fma_f32 v99, -v246, v83, v99
    v_fma_f32 v100, -v246, v84, v100
    v_mfma_f32_32x32x16_bf16 v[176:191], v[200:203], v[124:127], v[176:191]
    ds_read_b64_tr_b16 v[224:225], v245 offset:24704
    ds_read_b64_tr_b16 v[226:227], v245 offset:26240
    v_fma_f32 v101, -v246, v85, v101
    v_fma_f32 v102, -v246, v86, v102
    s_waitcnt vmcnt(3) lgkmcnt(6)
    v_mfma_f32_32x32x16_bf16 v[144:159], v[204:207], v[128:131], v[144:159]
    ds_read_b64_tr_b16 v[192:193], v247 offset:59392
    ds_read_b64_tr_b16 v[194:195], v247 offset:60928
    v_fma_f32 v103, -v246, v87, v103
    v_fma_f32 v104, -v246, v88, v104
    v_mfma_f32_32x32x16_bf16 v[160:175], v[208:211], v[128:131], v[160:175]
    ds_read_b64_tr_b16 v[196:197], v247 offset:59456
    ds_read_b64_tr_b16 v[198:199], v247 offset:60992
    v_fma_f32 v105, -v246, v89, v105
    v_fma_f32 v106, -v246, v90, v106
    v_mfma_f32_32x32x16_bf16 v[176:191], v[212:215], v[128:131], v[176:191]
    ds_read_b64_tr_b16 v[200:201], v247 offset:59520
    ds_read_b64_tr_b16 v[202:203], v247 offset:61056
    v_fma_f32 v107, -v246, v91, v107
    v_fma_f32 v108, -v246, v92, v108
    s_waitcnt vmcnt(2) lgkmcnt(6)
    v_mfma_f32_32x32x16_bf16 v[144:159], v[216:219], v[132:135], v[144:159]
    ds_read_b64_tr_b16 v[204:205], v247 offset:62464
    ds_read_b64_tr_b16 v[206:207], v247 offset:64000
    v_fma_f32 v109, -v246, v93, v109
    v_fma_f32 v110, -v246, v94, v110
    v_mfma_f32_32x32x16_bf16 v[160:175], v[220:223], v[132:135], v[160:175]
    ds_read_b64_tr_b16 v[208:209], v247 offset:62528
    ds_read_b64_tr_b16 v[210:211], v247 offset:64064
    v_fma_f32 v111, -v246, v95, v111
    v_mfma_f32_32x32x16_bf16 v[176:191], v[224:227], v[132:135], v[176:191]
    ds_read_b64_tr_b16 v[212:213], v247 offset:62592
    ds_read_b64_tr_b16 v[214:215], v247 offset:64128
    s_waitcnt vmcnt(1) lgkmcnt(6)
    v_mfma_f32_32x32x16_bf16 v[144:159], v[192:195], v[136:139], v[144:159]
    v_mfma_f32_32x32x16_bf16 v[160:175], v[196:199], v[136:139], v[160:175]
    v_mfma_f32_32x32x16_bf16 v[176:191], v[200:203], v[136:139], v[176:191]
    s_waitcnt vmcnt(0) lgkmcnt(0)
    v_mfma_f32_32x32x16_bf16 v[144:159], v[204:207], v[140:143], v[144:159]
    v_mfma_f32_32x32x16_bf16 v[160:175], v[208:211], v[140:143], v[160:175]
    v_mfma_f32_32x32x16_bf16 v[176:191], v[212:215], v[140:143], v[176:191]
    s_nop 9
    v_pk_fma_f32 v[144:145], v[144:145], v[248:249], v[32:33] op_sel_hi:[1,0,1]
    v_pk_fma_f32 v[146:147], v[146:147], v[248:249], v[34:35] op_sel_hi:[1,0,1]
    v_pk_fma_f32 v[148:149], v[148:149], v[248:249], v[36:37] op_sel_hi:[1,0,1]
    v_pk_fma_f32 v[150:151], v[150:151], v[248:249], v[38:39] op_sel_hi:[1,0,1]
    v_pk_fma_f32 v[152:153], v[152:153], v[248:249], v[40:41] op_sel_hi:[1,0,1]
    v_pk_fma_f32 v[154:155], v[154:155], v[248:249], v[42:43] op_sel_hi:[1,0,1]
    v_pk_fma_f32 v[156:157], v[156:157], v[248:249], v[44:45] op_sel_hi:[1,0,1]
    v_pk_fma_f32 v[158:159], v[158:159], v[248:249], v[46:47] op_sel_hi:[1,0,1]
    v_pk_mul_f32 v[120:121], v[144:145], v[144:145]
    v_pk_mul_f32 v[122:123], v[146:147], v[146:147]
    v_pk_mul_f32 v[124:125], v[148:149], v[148:149]
    v_pk_mul_f32 v[126:127], v[150:151], v[150:151]
    v_pk_mul_f32 v[128:129], v[152:153], v[152:153]
    v_pk_mul_f32 v[130:131], v[154:155], v[154:155]
    v_pk_mul_f32 v[132:133], v[156:157], v[156:157]
    v_pk_mul_f32 v[134:135], v[158:159], v[158:159]
    v_pk_fma_f32 v[120:121], v[120:121], v[232:233], v[232:233] op_sel:[0,1,0] op_sel_hi:[1,1,0]
    v_pk_fma_f32 v[122:123], v[122:123], v[232:233], v[232:233] op_sel:[0,1,0] op_sel_hi:[1,1,0]
    v_pk_fma_f32 v[124:125], v[124:125], v[232:233], v[232:233] op_sel:[0,1,0] op_sel_hi:[1,1,0]
    v_pk_fma_f32 v[126:127], v[126:127], v[232:233], v[232:233] op_sel:[0,1,0] op_sel_hi:[1,1,0]
    v_pk_fma_f32 v[128:129], v[128:129], v[232:233], v[232:233] op_sel:[0,1,0] op_sel_hi:[1,1,0]
    v_pk_fma_f32 v[130:131], v[130:131], v[232:233], v[232:233] op_sel:[0,1,0] op_sel_hi:[1,1,0]
    v_pk_fma_f32 v[132:133], v[132:133], v[232:233], v[232:233] op_sel:[0,1,0] op_sel_hi:[1,1,0]
    v_pk_fma_f32 v[134:135], v[134:135], v[232:233], v[232:233] op_sel:[0,1,0] op_sel_hi:[1,1,0]
    v_pk_mul_f32 v[120:121], v[120:121], v[144:145]
    v_pk_mul_f32 v[122:123], v[122:123], v[146:147]
    v_pk_mul_f32 v[124:125], v[124:125], v[148:149]
    v_pk_mul_f32 v[126:127], v[126:127], v[150:151]
    v_pk_mul_f32 v[128:129], v[128:129], v[152:153]
    v_pk_mul_f32 v[130:131], v[130:131], v[154:155]
    v_pk_mul_f32 v[132:133], v[132:133], v[156:157]
    v_pk_mul_f32 v[134:135], v[134:135], v[158:159]
    v_exp_f32 v120, v120
    v_exp_f32 v121, v121
    v_exp_f32 v122, v122
    v_exp_f32 v123, v123
    v_exp_f32 v124, v124
    v_exp_f32 v125, v125
    v_exp_f32 v126, v126
    v_exp_f32 v127, v127
    v_exp_f32 v128, v128
    v_exp_f32 v129, v129
    v_exp_f32 v130, v130
    v_exp_f32 v131, v131
    v_exp_f32 v132, v132
    v_exp_f32 v133, v133
    v_exp_f32 v134, v134
    v_exp_f32 v135, v135
    v_pk_add_f32 v[120:121], v[120:121], v[234:235] op_sel_hi:[1,0]
    v_pk_add_f32 v[122:123], v[122:123], v[234:235] op_sel_hi:[1,0]
    v_pk_add_f32 v[124:125], v[124:125], v[234:235] op_sel_hi:[1,0]
    v_pk_add_f32 v[126:127], v[126:127], v[234:235] op_sel_hi:[1,0]
    v_pk_add_f32 v[128:129], v[128:129], v[234:235] op_sel_hi:[1,0]
    v_pk_add_f32 v[130:131], v[130:131], v[234:235] op_sel_hi:[1,0]
    v_pk_add_f32 v[132:133], v[132:133], v[234:235] op_sel_hi:[1,0]
    v_pk_add_f32 v[134:135], v[134:135], v[234:235] op_sel_hi:[1,0]
    v_rcp_f32 v120, v120
    v_rcp_f32 v121, v121
    v_rcp_f32 v122, v122
    v_rcp_f32 v123, v123
    v_rcp_f32 v124, v124
    v_rcp_f32 v125, v125
    v_rcp_f32 v126, v126
    v_rcp_f32 v127, v127
    v_rcp_f32 v128, v128
    v_rcp_f32 v129, v129
    v_rcp_f32 v130, v130
    v_rcp_f32 v131, v131
    v_rcp_f32 v132, v132
    v_rcp_f32 v133, v133
    v_rcp_f32 v134, v134
    v_rcp_f32 v135, v135
    v_pk_mul_f32 v[144:145], v[144:145], v[120:121]
    v_pk_mul_f32 v[146:147], v[146:147], v[122:123]
    v_pk_mul_f32 v[148:149], v[148:149], v[124:125]
    v_pk_mul_f32 v[150:151], v[150:151], v[126:127]
    v_pk_mul_f32 v[152:153], v[152:153], v[128:129]
    v_pk_mul_f32 v[154:155], v[154:155], v[130:131]
    v_pk_mul_f32 v[156:157], v[156:157], v[132:133]
    v_pk_mul_f32 v[158:159], v[158:159], v[134:135]
    v_cvt_pk_bf16_f32 v192, v144, v145
    v_cvt_pk_bf16_f32 v193, v146, v147
    v_cvt_pk_bf16_f32 v194, v148, v149
    v_cvt_pk_bf16_f32 v195, v150, v151
    v_cvt_pk_bf16_f32 v196, v152, v153
    v_cvt_pk_bf16_f32 v197, v154, v155
    v_cvt_pk_bf16_f32 v198, v156, v157
    v_cvt_pk_bf16_f32 v199, v158, v159
    s_cmp_eq_u32 s3, 0
    s_cbranch_scc1 L_wt_95
    buffer_store_dwordx4 v[192:195], v1, s[4:7], s54 offen offset:0
    buffer_store_dwordx4 v[196:199], v1, s[4:7], s54 offen offset:1024
L_wtd_96:
    s_barrier
    v_pk_fma_f32 v[160:161], v[160:161], v[248:249], v[64:65] op_sel_hi:[1,0,1]
    v_pk_fma_f32 v[162:163], v[162:163], v[248:249], v[66:67] op_sel_hi:[1,0,1]
    v_pk_fma_f32 v[164:165], v[164:165], v[248:249], v[68:69] op_sel_hi:[1,0,1]
    v_pk_fma_f32 v[166:167], v[166:167], v[248:249], v[70:71] op_sel_hi:[1,0,1]
    v_pk_fma_f32 v[168:169], v[168:169], v[248:249], v[72:73] op_sel_hi:[1,0,1]
    v_pk_fma_f32 v[170:171], v[170:171], v[248:249], v[74:75] op_sel_hi:[1,0,1]
    v_pk_fma_f32 v[172:173], v[172:173], v[248:249], v[76:77] op_sel_hi:[1,0,1]
    v_pk_fma_f32 v[174:175], v[174:175], v[248:249], v[78:79] op_sel_hi:[1,0,1]
    v_pk_mul_f32 v[120:121], v[160:161], v[160:161]
    v_pk_mul_f32 v[122:123], v[162:163], v[162:163]
    v_pk_mul_f32 v[124:125], v[164:165], v[164:165]
    v_pk_mul_f32 v[126:127], v[166:167], v[166:167]
    v_pk_mul_f32 v[128:129], v[168:169], v[168:169]
    v_pk_mul_f32 v[130:131], v[170:171], v[170:171]
    v_pk_mul_f32 v[132:133], v[172:173], v[172:173]
    v_pk_mul_f32 v[134:135], v[174:175], v[174:175]
    v_pk_fma_f32 v[120:121], v[120:121], v[232:233], v[232:233] op_sel:[0,1,0] op_sel_hi:[1,1,0]
    v_pk_fma_f32 v[122:123], v[122:123], v[232:233], v[232:233] op_sel:[0,1,0] op_sel_hi:[1,1,0]
    v_pk_fma_f32 v[124:125], v[124:125], v[232:233], v[232:233] op_sel:[0,1,0] op_sel_hi:[1,1,0]
    v_pk_fma_f32 v[126:127], v[126:127], v[232:233], v[232:233] op_sel:[0,1,0] op_sel_hi:[1,1,0]
    v_pk_fma_f32 v[128:129], v[128:129], v[232:233], v[232:233] op_sel:[0,1,0] op_sel_hi:[1,1,0]
    v_pk_fma_f32 v[130:131], v[130:131], v[232:233], v[232:233] op_sel:[0,1,0] op_sel_hi:[1,1,0]
    v_pk_fma_f32 v[132:133], v[132:133], v[232:233], v[232:233] op_sel:[0,1,0] op_sel_hi:[1,1,0]
    v_pk_fma_f32 v[134:135], v[134:135], v[232:233], v[232:233] op_sel:[0,1,0] op_sel_hi:[1,1,0]
    v_pk_mul_f32 v[120:121], v[120:121], v[160:161]
    v_pk_mul_f32 v[122:123], v[122:123], v[162:163]
    v_pk_mul_f32 v[124:125], v[124:125], v[164:165]
    v_pk_mul_f32 v[126:127], v[126:127], v[166:167]
    v_pk_mul_f32 v[128:129], v[128:129], v[168:169]
    v_pk_mul_f32 v[130:131], v[130:131], v[170:171]
    v_pk_mul_f32 v[132:133], v[132:133], v[172:173]
    v_pk_mul_f32 v[134:135], v[134:135], v[174:175]
    v_exp_f32 v120, v120
    v_exp_f32 v121, v121
    v_exp_f32 v122, v122
    v_exp_f32 v123, v123
    v_exp_f32 v124, v124
    v_exp_f32 v125, v125
    v_exp_f32 v126, v126
    v_exp_f32 v127, v127
    v_exp_f32 v128, v128
    v_exp_f32 v129, v129
    v_exp_f32 v130, v130
    v_exp_f32 v131, v131
    v_exp_f32 v132, v132
    v_exp_f32 v133, v133
    v_exp_f32 v134, v134
    v_exp_f32 v135, v135
    v_pk_add_f32 v[120:121], v[120:121], v[234:235] op_sel_hi:[1,0]
    v_pk_add_f32 v[122:123], v[122:123], v[234:235] op_sel_hi:[1,0]
    v_pk_add_f32 v[124:125], v[124:125], v[234:235] op_sel_hi:[1,0]
    v_pk_add_f32 v[126:127], v[126:127], v[234:235] op_sel_hi:[1,0]
    v_pk_add_f32 v[128:129], v[128:129], v[234:235] op_sel_hi:[1,0]
    v_pk_add_f32 v[130:131], v[130:131], v[234:235] op_sel_hi:[1,0]
    v_pk_add_f32 v[132:133], v[132:133], v[234:235] op_sel_hi:[1,0]
    v_pk_add_f32 v[134:135], v[134:135], v[234:235] op_sel_hi:[1,0]
    v_rcp_f32 v120, v120
    v_rcp_f32 v121, v121
    v_rcp_f32 v122, v122
    v_rcp_f32 v123, v123
    v_rcp_f32 v124, v124
    v_rcp_f32 v125, v125
    v_rcp_f32 v126, v126
    v_rcp_f32 v127, v127
    v_rcp_f32 v128, v128
    v_rcp_f32 v129, v129
    v_rcp_f32 v130, v130
    v_rcp_f32 v131, v131
    v_rcp_f32 v132, v132
    v_rcp_f32 v133, v133
    v_rcp_f32 v134, v134
    v_rcp_f32 v135, v135
    v_pk_mul_f32 v[160:161], v[160:161], v[120:121]
    v_pk_mul_f32 v[162:163], v[162:163], v[122:123]
    v_pk_mul_f32 v[164:165], v[164:165], v[124:125]
    v_pk_mul_f32 v[166:167], v[166:167], v[126:127]
    v_pk_mul_f32 v[168:169], v[168:169], v[128:129]
    v_pk_mul_f32 v[170:171], v[170:171], v[130:131]
    v_pk_mul_f32 v[172:173], v[172:173], v[132:133]
    v_pk_mul_f32 v[174:175], v[174:175], v[134:135]
    v_cvt_pk_bf16_f32 v200, v160, v161
    v_cvt_pk_bf16_f32 v201, v162, v163
    v_cvt_pk_bf16_f32 v202, v164, v165
    v_cvt_pk_bf16_f32 v203, v166, v167
    v_cvt_pk_bf16_f32 v204, v168, v169
    v_cvt_pk_bf16_f32 v205, v170, v171
    v_cvt_pk_bf16_f32 v206, v172, v173
    v_cvt_pk_bf16_f32 v207, v174, v175
    s_cmp_eq_u32 s3, 0
    s_cbranch_scc1 L_wt_97
    buffer_store_dwordx4 v[200:203], v1, s[4:7], s54 offen offset:2048
    buffer_store_dwordx4 v[204:207], v1, s[4:7], s54 offen offset:3072
L_wtd_98:
    v_pk_fma_f32 v[176:177], v[176:177], v[248:249], v[96:97] op_sel_hi:[1,0,1]
    v_pk_fma_f32 v[178:179], v[178:179], v[248:249], v[98:99] op_sel_hi:[1,0,1]
    v_pk_fma_f32 v[180:181], v[180:181], v[248:249], v[100:101] op_sel_hi:[1,0,1]
    v_pk_fma_f32 v[182:183], v[182:183], v[248:249], v[102:103] op_sel_hi:[1,0,1]
    v_pk_fma_f32 v[184:185], v[184:185], v[248:249], v[104:105] op_sel_hi:[1,0,1]
    v_pk_fma_f32 v[186:187], v[186:187], v[248:249], v[106:107] op_sel_hi:[1,0,1]
    v_pk_fma_f32 v[188:189], v[188:189], v[248:249], v[108:109] op_sel_hi:[1,0,1]
    v_pk_fma_f32 v[190:191], v[190:191], v[248:249], v[110:111] op_sel_hi:[1,0,1]
    v_pk_mul_f32 v[120:121], v[176:177], v[176:177]
    v_pk_mul_f32 v[122:123], v[178:179], v[178:179]
    v_pk_mul_f32 v[124:125], v[180:181], v[180:181]
    v_pk_mul_f32 v[126:127], v[182:183], v[182:183]
    v_pk_mul_f32 v[128:129], v[184:185], v[184:185]
    v_pk_mul_f32 v[130:131], v[186:187], v[186:187]
    v_pk_mul_f32 v[132:133], v[188:189], v[188:189]
    v_pk_mul_f32 v[134:135], v[190:191], v[190:191]
    v_pk_fma_f32 v[120:121], v[120:121], v[232:233], v[232:233] op_sel:[0,1,0] op_sel_hi:[1,1,0]
    v_pk_fma_f32 v[122:123], v[122:123], v[232:233], v[232:233] op_sel:[0,1,0] op_sel_hi:[1,1,0]
    v_pk_fma_f32 v[124:125], v[124:125], v[232:233], v[232:233] op_sel:[0,1,0] op_sel_hi:[1,1,0]
    v_pk_fma_f32 v[126:127], v[126:127], v[232:233], v[232:233] op_sel:[0,1,0] op_sel_hi:[1,1,0]
    v_pk_fma_f32 v[128:129], v[128:129], v[232:233], v[232:233] op_sel:[0,1,0] op_sel_hi:[1,1,0]
    v_pk_fma_f32 v[130:131], v[130:131], v[232:233], v[232:233] op_sel:[0,1,0] op_sel_hi:[1,1,0]
    v_pk_fma_f32 v[132:133], v[132:133], v[232:233], v[232:233] op_sel:[0,1,0] op_sel_hi:[1,1,0]
    v_pk_fma_f32 v[134:135], v[134:135], v[232:233], v[232:233] op_sel:[0,1,0] op_sel_hi:[1,1,0]
    v_pk_mul_f32 v[120:121], v[120:121], v[176:177]
    v_pk_mul_f32 v[122:123], v[122:123], v[178:179]
    v_pk_mul_f32 v[124:125], v[124:125], v[180:181]
    v_pk_mul_f32 v[126:127], v[126:127], v[182:183]
    v_pk_mul_f32 v[128:129], v[128:129], v[184:185]
    v_pk_mul_f32 v[130:131], v[130:131], v[186:187]
    v_pk_mul_f32 v[132:133], v[132:133], v[188:189]
    v_pk_mul_f32 v[134:135], v[134:135], v[190:191]
    v_exp_f32 v120, v120
    v_exp_f32 v121, v121
    v_exp_f32 v122, v122
    v_exp_f32 v123, v123
    v_exp_f32 v124, v124
    v_exp_f32 v125, v125
    v_exp_f32 v126, v126
    v_exp_f32 v127, v127
    v_exp_f32 v128, v128
    v_exp_f32 v129, v129
    v_exp_f32 v130, v130
    v_exp_f32 v131, v131
    v_exp_f32 v132, v132
    v_exp_f32 v133, v133
    v_exp_f32 v134, v134
    v_exp_f32 v135, v135
    v_pk_add_f32 v[120:121], v[120:121], v[234:235] op_sel_hi:[1,0]
    v_pk_add_f32 v[122:123], v[122:123], v[234:235] op_sel_hi:[1,0]
    v_pk_add_f32 v[124:125], v[124:125], v[234:235] op_sel_hi:[1,0]
    v_pk_add_f32 v[126:127], v[126:127], v[234:235] op_sel_hi:[1,0]
    v_pk_add_f32 v[128:129], v[128:129], v[234:235] op_sel_hi:[1,0]
    v_pk_add_f32 v[130:131], v[130:131], v[234:235] op_sel_hi:[1,0]
    v_pk_add_f32 v[132:133], v[132:133], v[234:235] op_sel_hi:[1,0]
    v_pk_add_f32 v[134:135], v[134:135], v[234:235] op_sel_hi:[1,0]
    v_rcp_f32 v120, v120
    v_rcp_f32 v121, v121
    v_rcp_f32 v122, v122
    v_rcp_f32 v123, v123
    v_rcp_f32 v124, v124
    v_rcp_f32 v125, v125
    v_rcp_f32 v126, v126
    v_rcp_f32 v127, v127
    v_rcp_f32 v128, v128
    v_rcp_f32 v129, v129
    v_rcp_f32 v130, v130
    v_rcp_f32 v131, v131
    v_rcp_f32 v132, v132
    v_rcp_f32 v133, v133
    v_rcp_f32 v134, v134
    v_rcp_f32 v135, v135
    v_pk_mul_f32 v[176:177], v[176:177], v[120:121]
    v_pk_mul_f32 v[178:179], v[178:179], v[122:123]
    v_pk_mul_f32 v[180:181], v[180:181], v[124:125]
    v_pk_mul_f32 v[182:183], v[182:183], v[126:127]
    v_pk_mul_f32 v[184:185], v[184:185], v[128:129]
    v_pk_mul_f32 v[186:187], v[186:187], v[130:131]
    v_pk_mul_f32 v[188:189], v[188:189], v[132:133]
    v_pk_mul_f32 v[190:191], v[190:191], v[134:135]
    v_cvt_pk_bf16_f32 v208, v176, v177
    v_cvt_pk_bf16_f32 v209, v178, v179
    v_cvt_pk_bf16_f32 v210, v180, v181
    v_cvt_pk_bf16_f32 v211, v182, v183
    v_cvt_pk_bf16_f32 v212, v184, v185
    v_cvt_pk_bf16_f32 v213, v186, v187
    v_cvt_pk_bf16_f32 v214, v188, v189
    v_cvt_pk_bf16_f32 v215, v190, v191
    s_cmp_eq_u32 s3, 0
    s_cbranch_scc1 L_wt_99
    buffer_store_dwordx4 v[208:211], v1, s[4:7], s55 offen offset:0
    buffer_store_dwordx4 v[212:215], v1, s[4:7], s55 offen offset:1024
L_wtd_100:
L_f1_setup_92:
    s_mov_b32 s50, 0x27180
    s_mul_i32 s59, s45, 512
    s_add_u32 s50, s50, s59
    v_add_u32 v4, s50, v255
    ds_read_b128 v[160:163], v4 offset:0
    ds_read_b128 v[164:167], v4 offset:32
    ds_read_b128 v[168:171], v4 offset:64
    ds_read_b128 v[172:175], v4 offset:96
    v_lshlrev_b32 v144, 16, v8
    v_and_b32 v145, 0xffff0000, v8
    v_lshlrev_b32 v146, 16, v9
    v_and_b32 v147, 0xffff0000, v9
    v_lshlrev_b32 v148, 16, v10
    v_and_b32 v149, 0xffff0000, v10
    v_lshlrev_b32 v150, 16, v11
    v_and_b32 v151, 0xffff0000, v11
    v_lshlrev_b32 v152, 16, v12
    v_and_b32 v153, 0xffff0000, v12
    v_lshlrev_b32 v154, 16, v13
    v_and_b32 v155, 0xffff0000, v13
    v_lshlrev_b32 v156, 16, v14
    v_and_b32 v157, 0xffff0000, v14
    v_lshlrev_b32 v158, 16, v15
    v_and_b32 v159, 0xffff0000, v15
    v_bfe_u32 v244, v0, 2, 2
    v_lshrrev_b32 v6, 2, v255
    v_add_u32 v244, v244, v6
    v_mul_u32_u24 v244, 128, v244
    v_add_u32 v244, v244, v252
    v_bfe_u32 v6, v0, 3, 1
    v_xor_b32 v6, s45, v6
    v_lshl_or_b32 v244, v6, 6, v244
    s_mul_i32 s50, s45, 79872
    v_add_u32 v244, s50, v244
    v_xor_b32 v245, 64, v244
    v_add_u32 v247, 0x10000, v244
    v_add_u32 v249, 0x10000, v245
    v_and_b32 v4, 7, v0
    s_add_u32 s50, s38, 5120
    s_mul_i32 s59, s43, 128
    s_add_u32 s50, s50, s59
    s_mul_i32 s59, s45, 56
    s_add_u32 s50, s50, s59
    s_add_u32 s51, s37, 0x90000
    s_mul_i32 s59, s43, 99328
    s_add_u32 s51, s51, s59
    s_mul_i32 s59, s45, 44032
    s_add_u32 s51, s51, s59
    v_lshlrev_b32 v4, 3, v4
    s_waitcnt lgkmcnt(0)
    v_pk_add_f32 v[144:145], v[144:145], v[160:161]
    v_pk_add_f32 v[146:147], v[146:147], v[162:163]
    v_pk_add_f32 v[148:149], v[148:149], v[164:165]
    v_pk_add_f32 v[150:151], v[150:151], v[166:167]
    v_pk_add_f32 v[152:153], v[152:153], v[168:169]
    v_pk_add_f32 v[154:155], v[154:155], v[170:171]
    v_pk_add_f32 v[156:157], v[156:157], v[172:173]
    v_pk_add_f32 v[158:159], v[158:159], v[174:175]
    s_cmp_eq_u32 s42, 15
    s_cbranch_scc1 L_f1_done_90
    s_waitcnt vmcnt(0)
    s_mov_b64 exec, 1
    s_cmp_eq_u32 s3, 0
    s_cbranch_scc1 L_wt_101
    buffer_store_dwordx2 v[2:3], off, s[4:7], s56
L_wtd_102:
    s_mov_b64 exec, -1
    s_branch L_f1_done_90
L_f1_h_89:
    v_lshrrev_b32 v40, 3, v0
    v_mul_u32_u24 v40, 1024, v40
    v_and_b32 v6, 7, v0
    v_lshrrev_b32 v7, 2, v0
    v_and_b32 v7, 4, v7
    v_xor_b32 v6, v6, v7
    v_lshl_or_b32 v40, v6, 4, v40
    s_mov_b32 s8, s24
    s_and_b32 s9, s25, 0xffff
    s_mov_b32 s10, 0x158000
    s_mov_b32 s11, 0x20000
    s_waitcnt vmcnt(0) lgkmcnt(0)
    s_barrier
    s_cmp_lg_u32 s36, 0
    s_cbranch_scc1 L_fh1_103
    s_min_u32 s50, s49, 2
    s_lshl_b32 s50, s50, 7
    v_add_u32 v41, s50, v41
    v_add_u32 v42, 162304, v41
    ds_read_b32 v16, v42 offset:0
    ds_read_b32 v17, v42 offset:384
    ds_read_b32 v18, v42 offset:768
    ds_read_b32 v19, v42 offset:1152
    v_add_u32 v41, 160256, v41
    s_waitcnt lgkmcnt(0)
    v_add_f32 v16, v16, v17
    v_add_f32 v18, v18, v19
    v_add_f32 v16, v16, v18
    ds_write_b32 v41, v16
    s_waitcnt lgkmcnt(0)
L_fh1_103:
    s_barrier
    s_mov_b32 s50, 0x0
    s_mul_i32 s59, s49, 16384
    s_add_u32 s50, s50, s59
    s_mul_i32 s59, s44, 128
    s_add_u32 s50, s50, s59
    s_mov_b32 s51, 0x0
    s_mul_i32 s59, s49, 2048
    s_add_u32 s51, s51, s59
    s_mov_b32 s52, 2
L_dl_104:
    s_mov_b32 m0, s51
    s_add_u32 s51, s51, 1024
    buffer_load_dwordx4 v40, s[8:11], s50 offen lds
    s_add_u32 s50, s50, 8192
    s_waitcnt vmcnt(1)
    s_sub_u32 s52, s52, 1
    s_cmp_lg_u32 s52, 0
    s_cbranch_scc1 L_dl_104
    s_barrier
    s_mov_b32 s50, 0xac000
    s_mul_i32 s59, s49, 57344
    s_add_u32 s50, s50, s59
    s_mul_i32 s59, s44, 128
    s_add_u32 s50, s50, s59
    s_mov_b32 s51, 0x13800
    s_mul_i32 s59, s49, 7168
    s_add_u32 s51, s51, s59
    s_mov_b32 s52, 7
L_dl_105:
    s_mov_b32 m0, s51
    s_add_u32 s51, s51, 1024
    buffer_load_dwordx4 v40, s[8:11], s50 offen lds
    s_add_u32 s50, s50, 8192
    s_sub_u32 s52, s52, 1
    s_cmp_lg_u32 s52, 0
    s_cbranch_scc1 L_dl_105
    s_mov_b32 s50, 0x10000
    s_mul_i32 s59, s49, 98304
    s_add_u32 s50, s50, s59
    s_mul_i32 s59, s44, 128
    s_add_u32 s50, s50, s59
    s_mov_b32 s51, 0x2000
    s_mul_i32 s59, s49, 12288
    s_add_u32 s51, s51, s59
    s_mov_b32 s52, 12
L_dl_106:
    s_mov_b32 m0, s51
    s_add_u32 s51, s51, 1024
    buffer_load_dwordx4 v40, s[8:11], s50 offen lds
    s_add_u32 s50, s50, 8192
    s_sub_u32 s52, s52, 1
    s_cmp_lg_u32 s52, 0
    s_cbranch_scc1 L_dl_106
    s_mov_b32 s50, 0xe4000
    s_mul_i32 s59, s49, 49152
    s_add_u32 s50, s50, s59
    s_mul_i32 s59, s44, 128
    s_add_u32 s50, s50, s59
    s_mov_b32 s51, 0x1a800
    s_mul_i32 s59, s49, 6144
    s_add_u32 s51, s51, s59
    s_mov_b32 s52, 6
L_dl_107:
    s_mov_b32 m0, s51
    s_add_u32 s51, s51, 1024
    buffer_load_dwordx4 v40, s[8:11], s50 offen lds
    s_add_u32 s50, s50, 8192
    s_sub_u32 s52, s52, 1
    s_cmp_lg_u32 s52, 0
    s_cbranch_scc1 L_dl_107
    s_barrier
    s_mov_b32 s50, 0x6c000
    s_mul_i32 s59, s49, 49152
    s_add_u32 s50, s50, s59
    s_mul_i32 s59, s44, 128
    s_add_u32 s50, s50, s59
    s_mov_b32 s51, 0xd800
    s_mul_i32 s59, s49, 6144
    s_add_u32 s51, s51, s59
    s_mov_b32 s52, 6
L_dl_108:
    s_mov_b32 m0, s51
    s_add_u32 s51, s51, 1024
    buffer_load_dwordx4 v40, s[8:11], s50 offen lds
    s_add_u32 s50, s50, 8192
    s_waitcnt vmcnt(5)
    s_sub_u32 s52, s52, 1
    s_cmp_lg_u32 s52, 0
    s_cbranch_scc1 L_dl_108
    s_mov_b32 s50, 0x110000
    s_mul_i32 s59, s49, 57344
    s_add_u32 s50, s50, s59
    s_mul_i32 s59, s44, 128
    s_add_u32 s50, s50, s59
    s_mov_b32 s51, 0x20000
    s_mul_i32 s59, s49, 7168
    s_add_u32 s51, s51, s59
    s_mov_b32 s52, 7
L_dl_109:
    s_mov_b32 m0, s51
    s_add_u32 s51, s51, 1024
    buffer_load_dwordx4 v40, s[8:11], s50 offen lds
    s_add_u32 s50, s50, 8192
    s_waitcnt vmcnt(5)
    s_sub_u32 s52, s52, 1
    s_cmp_lg_u32 s52, 0
    s_cbranch_scc1 L_dl_109
L_f1_done_90:
    s_cmp_ge_u32 s34, 4
    s_cbranch_scc1 L_n_h_110
    s_barrier
    ds_read_b64_tr_b16 v[192:193], v244 offset:0
    ds_read_b64_tr_b16 v[194:195], v244 offset:1024
    ds_read_b64_tr_b16 v[196:197], v245 offset:0
    ds_read_b64_tr_b16 v[198:199], v245 offset:1024
    ds_read_b64_tr_b16 v[200:201], v244 offset:2048
    ds_read_b64_tr_b16 v[202:203], v244 offset:3072
    ds_read_b64_tr_b16 v[204:205], v245 offset:2048
    ds_read_b64_tr_b16 v[206:207], v245 offset:3072
    s_mov_b32 s60, 65536
    buffer_load_dwordx2 v[6:7], v4, s[4:7], s50 offen sc1
L_poll_112:
    buffer_load_dwordx2 v[16:17], v4, s[4:7], s50 offen sc1
    s_waitcnt vmcnt(1)
    v_cmp_eq_u64 vcc, v[6:7], v[2:3]
    s_nop 0
    s_cmp_eq_u64 vcc, -1
    s_cbranch_scc1 L_pok_113
    buffer_load_dwordx2 v[6:7], v4, s[4:7], s50 offen sc1
    s_waitcnt vmcnt(1)
    v_cmp_eq_u64 vcc, v[16:17], v[2:3]
    s_nop 0
    s_cmp_eq_u64 vcc, -1
    s_cbranch_scc1 L_pok_113
    s_sub_u32 s60, s60, 1
    s_cbranch_scc0 L_poll_112
    s_endpgm
L_pok_113:
    s_add_u32 s58, s51, 0
    buffer_load_dwordx4 v[16:19], v1, s[4:7], s58 offen offset:0 sc1
    buffer_load_dwordx4 v[20:23], v1, s[4:7], s58 offen offset:1024 sc1
    buffer_load_dwordx4 v[24:27], v1, s[4:7], s58 offen offset:2048 sc1
    buffer_load_dwordx4 v[28:31], v1, s[4:7], s58 offen offset:3072 sc1
    s_add_u32 s58, s51, 4096
    buffer_load_dwordx4 v[32:35], v1, s[4:7], s58 offen offset:0 sc1
    buffer_load_dwordx4 v[36:39], v1, s[4:7], s58 offen offset:1024 sc1
    buffer_load_dwordx4 v[40:43], v1, s[4:7], s58 offen offset:2048 sc1
    buffer_load_dwordx4 v[44:47], v1, s[4:7], s58 offen offset:3072 sc1
    s_add_u32 s58, s51, 8192
    buffer_load_dwordx4 v[48:51], v1, s[4:7], s58 offen offset:0 sc1
    buffer_load_dwordx4 v[52:55], v1, s[4:7], s58 offen offset:1024 sc1
    buffer_load_dwordx4 v[56:59], v1, s[4:7], s58 offen offset:2048 sc1
    buffer_load_dwordx4 v[60:63], v1, s[4:7], s58 offen offset:3072 sc1
    s_add_u32 s58, s51, 12288
    buffer_load_dwordx4 v[64:67], v1, s[4:7], s58 offen offset:0 sc1
    s_waitcnt vmcnt(12) lgkmcnt(4)
    v_mfma_f32_32x32x16_bf16 v[144:159], v[192:195], v[16:19], v[144:159]
    ds_read_b64_tr_b16 v[208:209], v244 offset:4096
    ds_read_b64_tr_b16 v[210:211], v244 offset:5120
    buffer_load_dwordx4 v[68:71], v1, s[4:7], s58 offen offset:1024 sc1
    v_mfma_f32_32x32x16_bf16 v[160:175], v[196:199], v[16:19], 0
    ds_read_b64_tr_b16 v[212:213], v245 offset:4096
    ds_read_b64_tr_b16 v[214:215], v245 offset:5120
    s_waitcnt vmcnt(12) lgkmcnt(4)
    v_mfma_f32_32x32x16_bf16 v[144:159], v[200:203], v[20:23], v[144:159]
    ds_read_b64_tr_b16 v[192:193], v244 offset:6144
    ds_read_b64_tr_b16 v[194:195], v244 offset:7168
    buffer_load_dwordx4 v[72:75], v1, s[4:7], s58 offen offset:2048 sc1
    v_mfma_f32_32x32x16_bf16 v[160:175], v[204:207], v[20:23], v[160:175]
    ds_read_b64_tr_b16 v[196:197], v245 offset:6144
    ds_read_b64_tr_b16 v[198:199], v245 offset:7168
    s_waitcnt vmcnt(12) lgkmcnt(4)
    v_mfma_f32_32x32x16_bf16 v[144:159], v[208:211], v[24:27], v[144:159]
    ds_read_b64_tr_b16 v[200:201], v244 offset:8192
    ds_read_b64_tr_b16 v[202:203], v244 offset:9216
    buffer_load_dwordx4 v[76:79], v1, s[4:7], s58 offen offset:3072 sc1
    s_and_b32 s52, s34, 1
    s_mov_b32 s50, 0x18000
    v_mfma_f32_32x32x16_bf16 v[160:175], v[212:215], v[24:27], v[160:175]
    ds_read_b64_tr_b16 v[204:205], v245 offset:8192
    ds_read_b64_tr_b16 v[206:207], v245 offset:9216
    s_mul_i32 s59, s52, 4096
    s_add_u32 s50, s50, s59
    s_waitcnt vmcnt(12) lgkmcnt(4)
    v_mfma_f32_32x32x16_bf16 v[144:159], v[192:195], v[28:31], v[144:159]
    ds_read_b64_tr_b16 v[208:209], v244 offset:10240
    ds_read_b64_tr_b16 v[210:211], v244 offset:11264
    s_add_u32 s58, s51, 16384
    buffer_load_dwordx4 v[80:83], v1, s[4:7], s58 offen offset:0 sc1
    s_mul_i32 s59, s45, 8192
    s_add_u32 s50, s50, s59
    v_mfma_f32_32x32x16_bf16 v[160:175], v[196:199], v[28:31], v[160:175]
    ds_read_b64_tr_b16 v[212:213], v245 offset:10240
    ds_read_b64_tr_b16 v[214:215], v245 offset:11264
    s_xor_b32 s53, s50, 8192
    s_add_u32 s54, s37, 0x0
    s_barrier
    s_waitcnt vmcnt(12) lgkmcnt(4)
    v_mfma_f32_32x32x16_bf16 v[144:159], v[200:203], v[32:35], v[144:159]
    ds_read_b64_tr_b16 v[192:193], v244 offset:12288
    ds_read_b64_tr_b16 v[194:195], v244 offset:13312
    buffer_load_dwordx4 v[84:87], v1, s[4:7], s58 offen offset:1024 sc1
    s_mul_i32 s59, s43, 33792
    s_add_u32 s54, s54, s59
    v_mfma_f32_32x32x16_bf16 v[160:175], v[204:207], v[32:35], v[160:175]
    ds_read_b64_tr_b16 v[196:197], v245 offset:12288
    ds_read_b64_tr_b16 v[198:199], v245 offset:13312
    s_mul_i32 s59, s46, 2048
    s_add_u32 s54, s54, s59
    s_waitcnt vmcnt(12) lgkmcnt(4)
    v_mfma_f32_32x32x16_bf16 v[144:159], v[208:211], v[36:39], v[144:159]
    ds_read_b64_tr_b16 v[200:201], v244 offset:14336
    ds_read_b64_tr_b16 v[202:203], v244 offset:15360
    buffer_load_dwordx4 v[88:91], v1, s[4:7], s58 offen offset:2048 sc1
    s_lshr_b32 s56, s46, 2
    s_and_b32 s57, s46, 3
    v_mfma_f32_32x32x16_bf16 v[160:175], v[212:215], v[36:39], v[160:175]
    ds_read_b64_tr_b16 v[204:205], v245 offset:14336
    ds_read_b64_tr_b16 v[206:207], v245 offset:15360
    s_add_u32 s55, s37, 0x158000
    s_mul_i32 s59, s43, 4096
    s_waitcnt vmcnt(12) lgkmcnt(4)
    v_mfma_f32_32x32x16_bf16 v[144:159], v[192:195], v[40:43], v[144:159]
    ds_read_b64_tr_b16 v[208:209], v244 offset:16384
    ds_read_b64_tr_b16 v[210:211], v244 offset:17408
    buffer_load_dwordx4 v[92:95], v1, s[4:7], s58 offen offset:3072 sc1
    s_add_u32 s55, s55, s59
    s_mul_i32 s59, s56, 1024
    v_mfma_f32_32x32x16_bf16 v[160:175], v[196:199], v[40:43], v[160:175]
    ds_read_b64_tr_b16 v[212:213], v245 offset:16384
    ds_read_b64_tr_b16 v[214:215], v245 offset:17408
    s_add_u32 s55, s55, s59
    s_mul_i32 s59, s57, 4
    s_waitcnt vmcnt(12) lgkmcnt(4)
    v_mfma_f32_32x32x16_bf16 v[144:159], v[200:203], v[44:47], v[144:159]
    ds_read_b64_tr_b16 v[192:193], v244 offset:18432
    ds_read_b64_tr_b16 v[194:195], v244 offset:19456
    s_add_u32 s58, s51, 20480
    buffer_load_dwordx4 v[96:99], v1, s[4:7], s58 offen offset:0 sc1
    s_add_u32 s55, s55, s59
    s_add_u32 s56, s38, 0
    v_mfma_f32_32x32x16_bf16 v[160:175], v[204:207], v[44:47], v[160:175]
    ds_read_b64_tr_b16 v[196:197], v245 offset:18432
    ds_read_b64_tr_b16 v[198:199], v245 offset:19456
    s_mul_i32 s59, s43, 128
    s_add_u32 s56, s56, s59
    s_waitcnt vmcnt(12) lgkmcnt(4)
    v_mfma_f32_32x32x16_bf16 v[144:159], v[208:211], v[48:51], v[144:159]
    ds_read_b64_tr_b16 v[200:201], v244 offset:20480
    ds_read_b64_tr_b16 v[202:203], v244 offset:21504
    buffer_load_dwordx4 v[100:103], v1, s[4:7], s58 offen offset:1024 sc1
    s_mul_i32 s59, s46, 8
    s_add_u32 s56, s56, s59
    v_mfma_f32_32x32x16_bf16 v[160:175], v[212:215], v[48:51], v[160:175]
    ds_read_b64_tr_b16 v[204:205], v245 offset:20480
    ds_read_b64_tr_b16 v[206:207], v245 offset:21504
    s_add_u32 s56, s56, 6144
    v_add_u32 v4, s50, v1
    s_waitcnt vmcnt(12) lgkmcnt(4)
    v_mfma_f32_32x32x16_bf16 v[144:159], v[192:195], v[52:55], v[144:159]
    ds_read_b64_tr_b16 v[208:209], v244 offset:22528
    ds_read_b64_tr_b16 v[210:211], v244 offset:23552
    buffer_load_dwordx4 v[104:107], v1, s[4:7], s58 offen offset:2048 sc1
    v_add_u32 v6, s53, v1
    v_mfma_f32_32x32x16_bf16 v[160:175], v[196:199], v[52:55], v[160:175]
    ds_read_b64_tr_b16 v[212:213], v245 offset:22528
    ds_read_b64_tr_b16 v[214:215], v245 offset:23552
    s_waitcnt vmcnt(12) lgkmcnt(4)
    v_mfma_f32_32x32x16_bf16 v[144:159], v[200:203], v[56:59], v[144:159]
    ds_read_b64_tr_b16 v[192:193], v244 offset:24576
    ds_read_b64_tr_b16 v[194:195], v244 offset:25600
    buffer_load_dwordx4 v[108:111], v1, s[4:7], s58 offen offset:3072 sc1
    v_mfma_f32_32x32x16_bf16 v[160:175], v[204:207], v[56:59], v[160:175]
    ds_read_b64_tr_b16 v[196:197], v245 offset:24576
    ds_read_b64_tr_b16 v[198:199], v245 offset:25600
    s_waitcnt vmcnt(12) lgkmcnt(4)
    v_mfma_f32_32x32x16_bf16 v[144:159], v[208:211], v[60:63], v[144:159]
    ds_read_b64_tr_b16 v[200:201], v244 offset:26624
    ds_read_b64_tr_b16 v[202:203], v244 offset:27648
    s_add_u32 s58, s51, 24576
    buffer_load_dwordx4 v[112:115], v1, s[4:7], s58 offen offset:0 sc1
    v_mfma_f32_32x32x16_bf16 v[160:175], v[212:215], v[60:63], v[160:175]
    ds_read_b64_tr_b16 v[204:205], v245 offset:26624
    ds_read_b64_tr_b16 v[206:207], v245 offset:27648
    s_waitcnt vmcnt(12) lgkmcnt(4)
    v_mfma_f32_32x32x16_bf16 v[144:159], v[192:195], v[64:67], v[144:159]
    ds_read_b64_tr_b16 v[208:209], v244 offset:28672
    ds_read_b64_tr_b16 v[210:211], v244 offset:29696
    buffer_load_dwordx4 v[116:119], v1, s[4:7], s58 offen offset:1024 sc1
    v_mfma_f32_32x32x16_bf16 v[160:175], v[196:199], v[64:67], v[160:175]
    ds_read_b64_tr_b16 v[212:213], v245 offset:28672
    ds_read_b64_tr_b16 v[214:215], v245 offset:29696
    s_waitcnt vmcnt(12) lgkmcnt(4)
    v_mfma_f32_32x32x16_bf16 v[144:159], v[200:203], v[68:71], v[144:159]
    ds_read_b64_tr_b16 v[192:193], v244 offset:30720
    ds_read_b64_tr_b16 v[194:195], v244 offset:31744
    buffer_load_dwordx4 v[120:123], v1, s[4:7], s58 offen offset:2048 sc1
    v_mfma_f32_32x32x16_bf16 v[160:175], v[204:207], v[68:71], v[160:175]
    ds_read_b64_tr_b16 v[196:197], v245 offset:30720
    ds_read_b64_tr_b16 v[198:199], v245 offset:31744
    s_waitcnt vmcnt(12) lgkmcnt(4)
    v_mfma_f32_32x32x16_bf16 v[144:159], v[208:211], v[72:75], v[144:159]
    ds_read_b64_tr_b16 v[200:201], v244 offset:32768
    ds_read_b64_tr_b16 v[202:203], v244 offset:33792
    buffer_load_dwordx4 v[124:127], v1, s[4:7], s58 offen offset:3072 sc1
    v_mfma_f32_32x32x16_bf16 v[160:175], v[212:215], v[72:75], v[160:175]
    ds_read_b64_tr_b16 v[204:205], v245 offset:32768
    ds_read_b64_tr_b16 v[206:207], v245 offset:33792
    s_waitcnt vmcnt(12) lgkmcnt(4)
    v_mfma_f32_32x32x16_bf16 v[144:159], v[192:195], v[76:79], v[144:159]
    ds_read_b64_tr_b16 v[208:209], v244 offset:34816
    ds_read_b64_tr_b16 v[210:211], v244 offset:35840
    s_add_u32 s58, s51, 28672
    buffer_load_dwordx4 v[128:131], v1, s[4:7], s58 offen offset:0 sc1
    v_mfma_f32_32x32x16_bf16 v[160:175], v[196:199], v[76:79], v[160:175]
    ds_read_b64_tr_b16 v[212:213], v245 offset:34816
    ds_read_b64_tr_b16 v[214:215], v245 offset:35840
    s_waitcnt vmcnt(12) lgkmcnt(4)
    v_mfma_f32_32x32x16_bf16 v[144:159], v[200:203], v[80:83], v[144:159]
    ds_read_b64_tr_b16 v[192:193], v244 offset:36864
    ds_read_b64_tr_b16 v[194:195], v244 offset:37888
    buffer_load_dwordx4 v[132:135], v1, s[4:7], s58 offen offset:1024 sc1
    v_mfma_f32_32x32x16_bf16 v[160:175], v[204:207], v[80:83], v[160:175]
    ds_read_b64_tr_b16 v[196:197], v245 offset:36864
    ds_read_b64_tr_b16 v[198:199], v245 offset:37888
    s_waitcnt vmcnt(12) lgkmcnt(4)
    v_mfma_f32_32x32x16_bf16 v[144:159], v[208:211], v[84:87], v[144:159]
    ds_read_b64_tr_b16 v[200:201], v244 offset:38912
    ds_read_b64_tr_b16 v[202:203], v244 offset:39936
    buffer_load_dwordx4 v[136:139], v1, s[4:7], s58 offen offset:2048 sc1
    v_mfma_f32_32x32x16_bf16 v[160:175], v[212:215], v[84:87], v[160:175]
    ds_read_b64_tr_b16 v[204:205], v245 offset:38912
    ds_read_b64_tr_b16 v[206:207], v245 offset:39936
    s_waitcnt vmcnt(12) lgkmcnt(4)
    v_mfma_f32_32x32x16_bf16 v[144:159], v[192:195], v[88:91], v[144:159]
    ds_read_b64_tr_b16 v[208:209], v244 offset:40960
    ds_read_b64_tr_b16 v[210:211], v244 offset:41984
    buffer_load_dwordx4 v[140:143], v1, s[4:7], s58 offen offset:3072 sc1
    v_mfma_f32_32x32x16_bf16 v[160:175], v[196:199], v[88:91], v[160:175]
    ds_read_b64_tr_b16 v[212:213], v245 offset:40960
    ds_read_b64_tr_b16 v[214:215], v245 offset:41984
    s_waitcnt vmcnt(12) lgkmcnt(4)
    v_mfma_f32_32x32x16_bf16 v[144:159], v[200:203], v[92:95], v[144:159]
    ds_read_b64_tr_b16 v[192:193], v244 offset:43008
    ds_read_b64_tr_b16 v[194:195], v244 offset:44032
    s_add_u32 s58, s51, 32768
    buffer_load_dwordx4 v[16:19], v1, s[4:7], s58 offen offset:0 sc1
    v_mfma_f32_32x32x16_bf16 v[160:175], v[204:207], v[92:95], v[160:175]
    ds_read_b64_tr_b16 v[196:197], v245 offset:43008
    ds_read_b64_tr_b16 v[198:199], v245 offset:44032
    s_waitcnt vmcnt(12) lgkmcnt(4)
    v_mfma_f32_32x32x16_bf16 v[144:159], v[208:211], v[96:99], v[144:159]
    ds_read_b64_tr_b16 v[200:201], v244 offset:45056
    ds_read_b64_tr_b16 v[202:203], v244 offset:46080
    buffer_load_dwordx4 v[20:23], v1, s[4:7], s58 offen offset:1024 sc1
    v_mfma_f32_32x32x16_bf16 v[160:175], v[212:215], v[96:99], v[160:175]
    ds_read_b64_tr_b16 v[204:205], v245 offset:45056
    ds_read_b64_tr_b16 v[206:207], v245 offset:46080
    s_waitcnt vmcnt(12) lgkmcnt(4)
    v_mfma_f32_32x32x16_bf16 v[144:159], v[192:195], v[100:103], v[144:159]
    ds_read_b64_tr_b16 v[208:209], v244 offset:47104
    ds_read_b64_tr_b16 v[210:211], v244 offset:48128
    buffer_load_dwordx4 v[24:27], v1, s[4:7], s58 offen offset:2048 sc1
    v_mfma_f32_32x32x16_bf16 v[160:175], v[196:199], v[100:103], v[160:175]
    ds_read_b64_tr_b16 v[212:213], v245 offset:47104
    ds_read_b64_tr_b16 v[214:215], v245 offset:48128
    s_waitcnt vmcnt(12) lgkmcnt(4)
    v_mfma_f32_32x32x16_bf16 v[144:159], v[200:203], v[104:107], v[144:159]
    ds_read_b64_tr_b16 v[192:193], v244 offset:49152
    ds_read_b64_tr_b16 v[194:195], v244 offset:50176
    buffer_load_dwordx4 v[28:31], v1, s[4:7], s58 offen offset:3072 sc1
    v_mfma_f32_32x32x16_bf16 v[160:175], v[204:207], v[104:107], v[160:175]
    ds_read_b64_tr_b16 v[196:197], v245 offset:49152
    ds_read_b64_tr_b16 v[198:199], v245 offset:50176
    s_waitcnt vmcnt(12) lgkmcnt(4)
    v_mfma_f32_32x32x16_bf16 v[144:159], v[208:211], v[108:111], v[144:159]
    ds_read_b64_tr_b16 v[200:201], v244 offset:51200
    ds_read_b64_tr_b16 v[202:203], v244 offset:52224
    s_add_u32 s58, s51, 36864
    buffer_load_dwordx4 v[32:35], v1, s[4:7], s58 offen offset:0 sc1
    v_mfma_f32_32x32x16_bf16 v[160:175], v[212:215], v[108:111], v[160:175]
    ds_read_b64_tr_b16 v[204:205], v245 offset:51200
    ds_read_b64_tr_b16 v[206:207], v245 offset:52224
    s_waitcnt vmcnt(12) lgkmcnt(4)
    v_mfma_f32_32x32x16_bf16 v[144:159], v[192:195], v[112:115], v[144:159]
    ds_read_b64_tr_b16 v[208:209], v244 offset:53248
    ds_read_b64_tr_b16 v[210:211], v244 offset:54272
    buffer_load_dwordx4 v[36:39], v1, s[4:7], s58 offen offset:1024 sc1
    v_mfma_f32_32x32x16_bf16 v[160:175], v[196:199], v[112:115], v[160:175]
    ds_read_b64_tr_b16 v[212:213], v245 offset:53248
    ds_read_b64_tr_b16 v[214:215], v245 offset:54272
    s_waitcnt vmcnt(12) lgkmcnt(4)
    v_mfma_f32_32x32x16_bf16 v[144:159], v[200:203], v[116:119], v[144:159]
    ds_read_b64_tr_b16 v[192:193], v244 offset:55296
    ds_read_b64_tr_b16 v[194:195], v244 offset:56320
    buffer_load_dwordx4 v[40:43], v1, s[4:7], s58 offen offset:2048 sc1
    v_mfma_f32_32x32x16_bf16 v[160:175], v[204:207], v[116:119], v[160:175]
    ds_read_b64_tr_b16 v[196:197], v245 offset:55296
    ds_read_b64_tr_b16 v[198:199], v245 offset:56320
    s_waitcnt vmcnt(12) lgkmcnt(4)
    v_mfma_f32_32x32x16_bf16 v[144:159], v[208:211], v[120:123], v[144:159]
    ds_read_b64_tr_b16 v[200:201], v244 offset:57344
    ds_read_b64_tr_b16 v[202:203], v244 offset:58368
    buffer_load_dwordx4 v[44:47], v1, s[4:7], s58 offen offset:3072 sc1
    v_mfma_f32_32x32x16_bf16 v[160:175], v[212:215], v[120:123], v[160:175]
    ds_read_b64_tr_b16 v[204:205], v245 offset:57344
    ds_read_b64_tr_b16 v[206:207], v245 offset:58368
    s_waitcnt vmcnt(12) lgkmcnt(4)
    v_mfma_f32_32x32x16_bf16 v[144:159], v[192:195], v[124:127], v[144:159]
    ds_read_b64_tr_b16 v[208:209], v244 offset:59392
    ds_read_b64_tr_b16 v[210:211], v244 offset:60416
    s_add_u32 s58, s51, 40960
    buffer_load_dwordx4 v[48:51], v1, s[4:7], s58 offen offset:0 sc1
    v_mfma_f32_32x32x16_bf16 v[160:175], v[196:199], v[124:127], v[160:175]
    ds_read_b64_tr_b16 v[212:213], v245 offset:59392
    ds_read_b64_tr_b16 v[214:215], v245 offset:60416
    s_waitcnt vmcnt(12) lgkmcnt(4)
    v_mfma_f32_32x32x16_bf16 v[144:159], v[200:203], v[128:131], v[144:159]
    ds_read_b64_tr_b16 v[192:193], v244 offset:61440
    ds_read_b64_tr_b16 v[194:195], v244 offset:62464
    buffer_load_dwordx4 v[52:55], v1, s[4:7], s58 offen offset:1024 sc1
    v_mfma_f32_32x32x16_bf16 v[160:175], v[204:207], v[128:131], v[160:175]
    ds_read_b64_tr_b16 v[196:197], v245 offset:61440
    ds_read_b64_tr_b16 v[198:199], v245 offset:62464
    s_waitcnt vmcnt(12) lgkmcnt(4)
    v_mfma_f32_32x32x16_bf16 v[144:159], v[208:211], v[132:135], v[144:159]
    ds_read_b64_tr_b16 v[200:201], v244 offset:63488
    ds_read_b64_tr_b16 v[202:203], v244 offset:64512
    buffer_load_dwordx4 v[56:59], v1, s[4:7], s58 offen offset:2048 sc1
    v_mfma_f32_32x32x16_bf16 v[160:175], v[212:215], v[132:135], v[160:175]
    ds_read_b64_tr_b16 v[204:205], v245 offset:63488
    ds_read_b64_tr_b16 v[206:207], v245 offset:64512
    s_waitcnt vmcnt(12) lgkmcnt(4)
    v_mfma_f32_32x32x16_bf16 v[144:159], v[192:195], v[136:139], v[144:159]
    ds_read_b64_tr_b16 v[208:209], v247 offset:0
    ds_read_b64_tr_b16 v[210:211], v247 offset:1024
    v_mfma_f32_32x32x16_bf16 v[160:175], v[196:199], v[136:139], v[160:175]
    ds_read_b64_tr_b16 v[212:213], v249 offset:0
    ds_read_b64_tr_b16 v[214:215], v249 offset:1024
    s_waitcnt vmcnt(11) lgkmcnt(4)
    v_mfma_f32_32x32x16_bf16 v[144:159], v[200:203], v[140:143], v[144:159]
    ds_read_b64_tr_b16 v[192:193], v247 offset:2048
    ds_read_b64_tr_b16 v[194:195], v247 offset:3072
    v_mfma_f32_32x32x16_bf16 v[160:175], v[204:207], v[140:143], v[160:175]
    ds_read_b64_tr_b16 v[196:197], v249 offset:2048
    ds_read_b64_tr_b16 v[198:199], v249 offset:3072
    s_waitcnt vmcnt(10) lgkmcnt(4)
    v_mfma_f32_32x32x16_bf16 v[144:159], v[208:211], v[16:19], v[144:159]
    ds_read_b64_tr_b16 v[200:201], v247 offset:4096
    ds_read_b64_tr_b16 v[202:203], v247 offset:5120
    v_mfma_f32_32x32x16_bf16 v[160:175], v[212:215], v[16:19], v[160:175]
    ds_read_b64_tr_b16 v[204:205], v249 offset:4096
    ds_read_b64_tr_b16 v[206:207], v249 offset:5120
    s_waitcnt vmcnt(9) lgkmcnt(4)
    v_mfma_f32_32x32x16_bf16 v[144:159], v[192:195], v[20:23], v[144:159]
    ds_read_b64_tr_b16 v[208:209], v247 offset:6144
    ds_read_b64_tr_b16 v[210:211], v247 offset:7168
    v_mfma_f32_32x32x16_bf16 v[160:175], v[196:199], v[20:23], v[160:175]
    ds_read_b64_tr_b16 v[212:213], v249 offset:6144
    ds_read_b64_tr_b16 v[214:215], v249 offset:7168
    s_waitcnt vmcnt(8) lgkmcnt(4)
    v_mfma_f32_32x32x16_bf16 v[144:159], v[200:203], v[24:27], v[144:159]
    ds_read_b64_tr_b16 v[192:193], v247 offset:8192
    ds_read_b64_tr_b16 v[194:195], v247 offset:9216
    v_mfma_f32_32x32x16_bf16 v[160:175], v[204:207], v[24:27], v[160:175]
    ds_read_b64_tr_b16 v[196:197], v249 offset:8192
    ds_read_b64_tr_b16 v[198:199], v249 offset:9216
    s_waitcnt vmcnt(7) lgkmcnt(4)
    v_mfma_f32_32x32x16_bf16 v[144:159], v[208:211], v[28:31], v[144:159]
    ds_read_b64_tr_b16 v[200:201], v247 offset:10240
    ds_read_b64_tr_b16 v[202:203], v247 offset:11264
    v_mfma_f32_32x32x16_bf16 v[160:175], v[212:215], v[28:31], v[160:175]
    ds_read_b64_tr_b16 v[204:205], v249 offset:10240
    ds_read_b64_tr_b16 v[206:207], v249 offset:11264
    s_waitcnt vmcnt(6) lgkmcnt(4)
    v_mfma_f32_32x32x16_bf16 v[144:159], v[192:195], v[32:35], v[144:159]
    ds_read_b64_tr_b16 v[208:209], v247 offset:12288
    ds_read_b64_tr_b16 v[210:211], v247 offset:13312
    v_mfma_f32_32x32x16_bf16 v[160:175], v[196:199], v[32:35], v[160:175]
    ds_read_b64_tr_b16 v[212:213], v249 offset:12288
    ds_read_b64_tr_b16 v[214:215], v249 offset:13312
    s_barrier
    s_waitcnt vmcnt(5) lgkmcnt(4)
    v_mfma_f32_32x32x16_bf16 v[144:159], v[200:203], v[36:39], v[144:159]
    ds_read_b64_tr_b16 v[192:193], v244 offset:0
    ds_read_b64_tr_b16 v[194:195], v244 offset:1024
    v_mfma_f32_32x32x16_bf16 v[160:175], v[204:207], v[36:39], v[160:175]
    ds_read_b64_tr_b16 v[196:197], v245 offset:0
    ds_read_b64_tr_b16 v[198:199], v245 offset:1024
    s_waitcnt vmcnt(4) lgkmcnt(4)
    v_mfma_f32_32x32x16_bf16 v[144:159], v[208:211], v[40:43], v[144:159]
    ds_read_b64_tr_b16 v[200:201], v244 offset:2048
    ds_read_b64_tr_b16 v[202:203], v244 offset:3072
    v_mfma_f32_32x32x16_bf16 v[160:175], v[212:215], v[40:43], v[160:175]
    ds_read_b64_tr_b16 v[204:205], v245 offset:2048
    ds_read_b64_tr_b16 v[206:207], v245 offset:3072
    s_waitcnt vmcnt(3) lgkmcnt(4)
    v_mfma_f32_32x32x16_bf16 v[144:159], v[192:195], v[44:47], v[144:159]
    ds_read_b64_tr_b16 v[208:209], v244 offset:4096
    ds_read_b64_tr_b16 v[210:211], v244 offset:5120
    v_mfma_f32_32x32x16_bf16 v[160:175], v[196:199], v[44:47], v[160:175]
    ds_read_b64_tr_b16 v[212:213], v245 offset:4096
    ds_read_b64_tr_b16 v[214:215], v245 offset:5120
    s_waitcnt vmcnt(2) lgkmcnt(4)
    v_mfma_f32_32x32x16_bf16 v[144:159], v[200:203], v[48:51], v[144:159]
    ds_read_b64_tr_b16 v[192:193], v244 offset:6144
    ds_read_b64_tr_b16 v[194:195], v244 offset:7168
    v_mfma_f32_32x32x16_bf16 v[160:175], v[204:207], v[48:51], v[160:175]
    ds_read_b64_tr_b16 v[196:197], v245 offset:6144
    ds_read_b64_tr_b16 v[198:199], v245 offset:7168
    s_waitcnt vmcnt(0) lgkmcnt(0)
    v_mfma_f32_32x32x16_bf16 v[160:175], v[212:215], v[52:55], v[160:175]
    v_mfma_f32_32x32x16_bf16 v[160:175], v[196:199], v[56:59], v[160:175]
    v_mfma_f32_32x32x16_bf16 v[144:159], v[208:211], v[52:55], v[144:159]
    v_mfma_f32_32x32x16_bf16 v[144:159], v[192:195], v[56:59], v[144:159]
    s_nop 9
    ds_write_b128 v4, v[160:163] offset:0
    ds_write_b128 v4, v[164:167] offset:1024
    ds_write_b128 v4, v[168:171] offset:2048
    ds_write_b128 v4, v[172:175] offset:3072
    s_waitcnt lgkmcnt(0)
    s_barrier
    ds_read_b128 v[160:163], v6 offset:0
    ds_read_b128 v[164:167], v6 offset:1024
    ds_read_b128 v[168:171], v6 offset:2048
    ds_read_b128 v[172:175], v6 offset:3072
    s_waitcnt lgkmcnt(3)
    v_pk_add_f32 v[144:145], v[144:145], v[160:161]
    v_pk_add_f32 v[146:147], v[146:147], v[162:163]
    s_waitcnt lgkmcnt(2)
    v_pk_add_f32 v[148:149], v[148:149], v[164:165]
    v_pk_add_f32 v[150:151], v[150:151], v[166:167]
    s_waitcnt lgkmcnt(1)
    v_pk_add_f32 v[152:153], v[152:153], v[168:169]
    v_pk_add_f32 v[154:155], v[154:155], v[170:171]
    s_waitcnt lgkmcnt(0)
    v_pk_add_f32 v[156:157], v[156:157], v[172:173]
    v_pk_add_f32 v[158:159], v[158:159], v[174:175]
    v_cvt_pk_bf16_f32 v8, v144, v145
    v_cvt_pk_bf16_f32 v9, v146, v147
    v_cvt_pk_bf16_f32 v10, v148, v149
    v_cvt_pk_bf16_f32 v11, v150, v151
    v_cvt_pk_bf16_f32 v12, v152, v153
    v_cvt_pk_bf16_f32 v13, v154, v155
    v_cvt_pk_bf16_f32 v14, v156, v157
    v_cvt_pk_bf16_f32 v15, v158, v159
    s_cmp_lg_u32 s36, 0
    s_cbranch_scc1 L_last_114
    s_cmp_eq_u32 s3, 0
    s_cbranch_scc1 L_wt_115
    buffer_store_dwordx4 v[8:11], v1, s[4:7], s54 offen
    buffer_store_dwordx4 v[12:15], v1, s[4:7], s54 offen offset:1024
L_wtd_116:
    v_pk_add_f32 v[20:21], v[144:145], v[146:147]
    v_pk_mul_f32 v[22:23], v[144:145], v[144:145]
    v_pk_fma_f32 v[22:23], v[146:147], v[146:147], v[22:23]
    v_pk_add_f32 v[20:21], v[20:21], v[148:149]
    v_pk_fma_f32 v[22:23], v[148:149], v[148:149], v[22:23]
    v_pk_add_f32 v[20:21], v[20:21], v[150:151]
    v_pk_fma_f32 v[22:23], v[150:151], v[150:151], v[22:23]
    v_pk_add_f32 v[20:21], v[20:21], v[152:153]
    v_pk_fma_f32 v[22:23], v[152:153], v[152:153], v[22:23]
    v_pk_add_f32 v[20:21], v[20:21], v[154:155]
    v_pk_fma_f32 v[22:23], v[154:155], v[154:155], v[22:23]
    v_pk_add_f32 v[20:21], v[20:21], v[156:157]
    v_pk_fma_f32 v[22:23], v[156:157], v[156:157], v[22:23]
    v_pk_add_f32 v[20:21], v[20:21], v[158:159]
    v_pk_fma_f32 v[22:23], v[158:159], v[158:159], v[22:23]
    v_add_f32 v20, v20, v21
    v_add_f32 v22, v22, v23
    s_nop 1
    v_permlane32_swap_b32 v20, v22
    s_nop 1
    v_add_f32 v20, v20, v22
    s_cmp_eq_u32 s3, 0
    s_cbranch_scc1 L_wt_117
    buffer_store_dword v20, v1, s[4:7], s55 offen
L_wtd_118:
    v_and_b32 v4, 15, v0
    v_lshlrev_b32 v4, 3, v4
    s_add_u32 s50, s38, 6144
    s_mul_i32 s59, s41, 128
    s_add_u32 s50, s50, s59
    s_add_u32 s51, s37, 0x0
    s_mul_i32 s59, s41, 33792
    s_add_u32 s51, s51, s59
    s_add_u32 s52, s37, 0x158000
    s_mul_i32 s59, s41, 4096
    s_add_u32 s52, s52, s59
    v_add_u32 v251, 159744, v255
    v_bfe_u32 v244, v0, 2, 2
    v_lshrrev_b32 v6, 2, v255
    v_add_u32 v244, v244, v6
    v_mul_u32_u24 v244, 128, v244
    v_add_u32 v244, v244, v252
    v_bfe_u32 v6, v0, 3, 1
    v_lshl_or_b32 v244, v6, 6, v244
    v_xor_b32 v247, 64, v244
    v_bfe_u32 v245, v0, 2, 2
    v_lshrrev_b32 v6, 2, v255
    v_add_u32 v245, v245, v6
    v_mul_u32_u24 v245, 64, v245
    v_add_u32 v245, v245, v252
    v_add_u32 v245, 0x10000, v245
    s_waitcnt vmcnt(0)
    s_mov_b64 exec, 1
    s_cmp_eq_u32 s3, 0
    s_cbranch_scc1 L_wt_119
    buffer_store_dwordx2 v[2:3], off, s[4:7], s56
L_wtd_120:
    s_mov_b64 exec, -1
    s_branch L_n_done_111
L_last_114:
    s_mov_b32 s8, s28
    s_and_b32 s9, s29, 0xffff
    s_mov_b32 s10, 0x200000
    s_mov_b32 s11, 0x20000
    v_and_b32 v16, 31, v0
    v_lshlrev_b32 v16, 10, v16
    v_add_u32 v16, v16, v255
    s_mov_b32 s50, 0x0
    s_mul_i32 s59, s39, 262144
    s_add_u32 s50, s50, s59
    s_mul_i32 s59, s43, 32768
    s_add_u32 s50, s50, s59
    s_mul_i32 s59, s46, 64
    s_add_u32 s50, s50, s59
    v_permlane32_swap_b32 v8, v10
    v_permlane32_swap_b32 v9, v11
    v_permlane32_swap_b32 v12, v14
    v_permlane32_swap_b32 v13, v15
    buffer_store_dwordx4 v[8:11], v16, s[8:11], s50 offen offset:0
    buffer_store_dwordx4 v[12:15], v16, s[8:11], s50 offen offset:32
    s_branch L_n_done_111
L_n_h_110:
    s_waitcnt vmcnt(0)
    s_barrier
    s_lshr_b32 s53, s49, 1
    s_and_b32 s54, s49, 1
    s_mov_b32 s50, 0x9c000
    s_mul_i32 s59, s53, 704512
    s_add_u32 s50, s50, s59
    s_mul_i32 s59, s54, 32768
    s_add_u32 s50, s50, s59
    s_mul_i32 s59, s44, 128
    s_add_u32 s50, s50, s59
    s_mov_b32 s51, 0x0
    s_mul_i32 s59, s53, 79872
    s_add_u32 s51, s51, s59
    s_mul_i32 s59, s54, 4096
    s_add_u32 s51, s51, s59
    s_barrier
    s_add_u32 m0, s51, 0
    s_nop 0
    buffer_load_dwordx4 v40, s[8:11], s50 offen lds
    s_add_u32 s50, s50, 8192
    s_add_u32 m0, s51, 1024
    s_nop 0
    buffer_load_dwordx4 v40, s[8:11], s50 offen lds
    s_add_u32 s50, s50, 8192
    s_add_u32 m0, s51, 2048
    s_nop 0
    buffer_load_dwordx4 v40, s[8:11], s50 offen lds
    s_add_u32 s50, s50, 8192
    s_add_u32 m0, s51, 3072
    s_nop 0
    buffer_load_dwordx4 v40, s[8:11], s50 offen lds
    s_add_u32 s50, s50, 8192
    s_waitcnt vmcnt(0)
    s_barrier
    s_mul_i32 s50, s49, 24576
    v_add_u32 v42, s50, v1
    s_barrier
    s_cmp_lg_u32 s36, 0
    s_cbranch_scc1 L_n_done_111
    ds_write_b128 v42, v[128:131] offset:0
    ds_write_b128 v42, v[132:135] offset:1024
    ds_write_b128 v42, v[136:139] offset:2048
    ds_write_b128 v42, v[140:143] offset:3072
    ds_write_b128 v42, v[144:147] offset:4096
    ds_write_b128 v42, v[148:151] offset:5120
    ds_write_b128 v42, v[152:155] offset:6144
    ds_write_b128 v42, v[156:159] offset:7168
    ds_write_b128 v42, v[160:163] offset:8192
    ds_write_b128 v42, v[164:167] offset:9216
    ds_write_b128 v42, v[168:171] offset:10240
    ds_write_b128 v42, v[172:175] offset:11264
    ds_write_b128 v42, v[176:179] offset:12288
    ds_write_b128 v42, v[180:183] offset:13312
    ds_write_b128 v42, v[184:187] offset:14336
    ds_write_b128 v42, v[188:191] offset:15360
    ds_write_b128 v42, v[192:195] offset:16384
    ds_write_b128 v42, v[196:199] offset:17408
    ds_write_b128 v42, v[200:203] offset:18432
    ds_write_b128 v42, v[204:207] offset:19456
    ds_write_b128 v42, v[208:211] offset:20480
    ds_write_b128 v42, v[212:215] offset:21504
    ds_write_b128 v42, v[216:219] offset:22528
    ds_write_b128 v42, v[220:223] offset:23552
L_n_done_111:
    s_add_u32 s36, s36, 1
    s_add_u32 s38, s38, 6144
    s_cmp_lt_u32 s36, 2
    s_cbranch_scc1 L_layer
    s_or_b32 s50, s2, s34
    s_cmp_lg_u32 s50, 0
    s_cbranch_scc1 L_end
    s_mov_b64 exec, 1
    buffer_store_dword v2, off, s[4:7], 0
L_end:
    s_endpgm
L_chk_55:
    s_waitcnt vmcnt(0)
    v_cmp_eq_u64 vcc, v[6:7], v[2:3]
    s_nop 1
    s_cmp_eq_u64 vcc, -1
    s_cbranch_scc1 L_iss_57
    buffer_load_dwordx2 v[6:7], v106, s[4:7], s55 offen sc1
    s_sub_u32 s60, s60, 1
    s_cbranch_scc0 L_chk_55
    s_endpgm
L_iss_57:
    s_and_b32 s54, s54, 7
    s_lshl_b32 s59, s54, 14
    s_add_u32 s53, s53, 16384
    s_add_u32 s59, s59, s52
    s_mov_b32 m0, s53
    s_add_u32 s54, s54, 1
    buffer_load_dwordx4 v1, s[4:7], s59 offen offset:0 sc1 lds
    buffer_load_dwordx4 v1, s[4:7], s59 offen offset:1024 sc1 lds
    buffer_load_dwordx4 v1, s[4:7], s59 offen offset:2048 sc1 lds
    buffer_load_dwordx4 v1, s[4:7], s59 offen offset:3072 sc1 lds
    s_mov_b32 s56, 1
    s_branch L_chkb_56
L_sc_62:
    s_and_b32 s54, s54, 7
    s_lshl_b32 s59, s54, 14
    s_add_u32 s53, s53, 16384
    s_add_u32 s59, s59, s52
    s_mov_b32 m0, s53
    s_add_u32 s54, s54, 1
    buffer_load_dwordx4 v1, s[4:7], s59 offen offset:0 sc1 nt lds
    buffer_load_dwordx4 v1, s[4:7], s59 offen offset:1024 sc1 nt lds
    buffer_load_dwordx4 v1, s[4:7], s59 offen offset:2048 sc1 nt lds
    buffer_load_dwordx4 v1, s[4:7], s59 offen offset:3072 sc1 nt lds
    s_mov_b32 s56, 2
    s_branch L_scb_63
L_wt_8:
    buffer_store_dwordx4 v[8:11], v1, s[4:7], s54 offen sc1
    buffer_store_dwordx4 v[12:15], v1, s[4:7], s54 offen offset:1024 sc1
    s_branch L_wtd_9
L_wt_10:
    buffer_store_dword v84, v1, s[4:7], s55 offen sc1
    s_branch L_wtd_11
L_wt_12:
    buffer_store_dwordx2 v[2:3], off, s[4:7], s56 sc1
    s_branch L_wtd_13
L_wt_23:
    buffer_store_dwordx4 v[8:11], v1, s[4:7], s54 offen sc1
    buffer_store_dwordx4 v[12:15], v1, s[4:7], s54 offen offset:1024 sc1
    s_branch L_wtd_24
L_wt_25:
    buffer_store_dword v84, v1, s[4:7], s55 offen sc1
    s_branch L_wtd_26
L_wt_27:
    buffer_store_dwordx2 v[2:3], off, s[4:7], s56 sc1
    s_branch L_wtd_28
L_wt_33:
    buffer_store_dwordx4 v[16:19], v7, s[4:7], s52 offen offset:1024 sc1
    buffer_store_dwordx4 v[20:23], v7, s[4:7], s52 offen offset:1280 sc1
    buffer_store_dwordx4 v[24:27], v7, s[4:7], s50 offen offset:1024 sc1
    buffer_store_dwordx4 v[28:31], v7, s[4:7], s50 offen offset:1280 sc1
    s_branch L_wtd_34
L_wt_35:
    buffer_store_dwordx4 v[48:51], v1, s[4:7], s53 offen offset:0 sc1
    buffer_store_dwordx4 v[52:55], v1, s[4:7], s53 offen offset:1024 sc1
    s_branch L_wtd_36
L_wt_37:
    buffer_store_dwordx2 v[2:3], off, s[4:7], s56 sc1
    s_branch L_wtd_38
L_wt_39:
    buffer_store_dwordx4 v[16:19], v253, s[4:7], s52 offen offset:0 sc1
    buffer_store_dwordx4 v[20:23], v253, s[4:7], s52 offen offset:2048 sc1
    buffer_store_dwordx4 v[24:27], v253, s[4:7], s50 offen offset:0 sc1
    buffer_store_dwordx4 v[28:31], v253, s[4:7], s50 offen offset:2048 sc1
    s_branch L_wtd_40
L_wt_41:
    buffer_store_dwordx4 v[48:51], v1, s[4:7], s53 offen offset:0 sc1
    buffer_store_dwordx4 v[52:55], v1, s[4:7], s53 offen offset:1024 sc1
    s_branch L_wtd_42
L_wt_43:
    buffer_store_dwordx2 v[2:3], off, s[4:7], s56 sc1
    s_branch L_wtd_44
L_wp_61:
    s_cmp_lg_u32 s61, 3
    s_cbranch_scc1 L_kvs_58
    s_mov_b32 s64, s16
    s_and_b32 s65, s17, 0xffff
    s_mov_b32 s66, 0x80000
    s_mov_b32 s67, 0x20000
    s_mov_b32 s51, 0x0
    s_mul_i32 s59, s40, 16384
    s_add_u32 s51, s51, s59
    s_mul_i32 s59, s34, 4096
    s_add_u32 s51, s51, s59
    v_lshrrev_b32 v103, 3, v0
    v_mul_u32_u24 v103, 32768, v103
    v_add_u32 v103, v103, v100
    s_add_u32 s50, s37, 0x48000
    s_mul_i32 s59, s34, 67584
    s_add_u32 s50, s50, s59
    s_mul_i32 s59, s47, 1024
    s_add_u32 s50, s50, s59
    s_mov_b64 exec, 0xffff
    buffer_load_dword v102, v103, s[4:7], s50 offen sc1
    s_mov_b64 exec, -1
    s_mov_b32 exec_hi, 0
    buffer_load_dword v102, v100, s[64:67], s51 offen
    s_mov_b64 exec, -1
    s_branch L_kvs_58
L_ft_60:
    s_cmp_lg_u32 s61, s58
    s_cbranch_scc1 L_wp_61
    buffer_load_dword v102, v100, s[64:67], s51 offen
    s_branch L_kvs_58
L_kvc_59:
    s_cmp_lt_u32 s61, 4
    s_cbranch_scc1 L_ft_60
    s_mov_b32 exec_hi, 0
    buffer_load_dword v102, v101, s[8:11], s57 offen
    s_mov_b64 exec, -1
    s_add_u32 s57, s57, 44032
    s_branch L_kvs_58
L_wt_66:
    buffer_store_dwordx4 v[20:23], v1, s[4:7], s54 offen sc1
    s_branch L_wtd_67
L_wt_69:
    buffer_store_dwordx2 v[2:3], off, s[4:7], s55 sc1
    s_branch L_wtd_70
L_att_slow_65:
    s_mov_b32 s52, 0x200000
    s_mul_i32 s59, s36, 4194304
    s_add_u32 s52, s52, s59
    s_mul_i32 s59, s47, 131072
    s_add_u32 s52, s52, s59
    v_mov_b32 v100, 0xff800000
    s_mov_b32 s61, 0
L_slow1_71:
    buffer_load_dwordx4 v[68:71], v1, s[4:7], s52 offen sc1
    s_waitcnt vmcnt(0)
    v_mfma_f32_32x32x16_bf16 v[16:31], v[68:71], v[64:67], 0
    s_nop 15
    v_max3_f32 v100, v16, v17, v100
    v_max3_f32 v100, v18, v19, v100
    v_max3_f32 v100, v20, v21, v100
    v_max3_f32 v100, v22, v23, v100
    v_max3_f32 v100, v24, v25, v100
    v_max3_f32 v100, v26, v27, v100
    v_max3_f32 v100, v28, v29, v100
    v_max3_f32 v100, v30, v31, v100
    s_add_u32 s52, s52, 2048
    s_add_u32 s61, s61, 1
    s_cmp_lt_u32 s61, 64
    s_cbranch_scc1 L_slow1_71
    v_mov_b32 v101, v100
    s_nop 1
    v_permlane32_swap_b32 v100, v101
    s_nop 1
    v_max_f32 v100, v100, v101
    v_sub_f32 v100, 0, v100
    v_mov_b32 v101, v100
    v_mov_b32 v102, v100
    v_mov_b32 v103, v100
    v_mov_b32 v104, v100
    v_mov_b32 v105, v100
    v_mov_b32 v106, v100
    v_mov_b32 v107, v100
    v_mov_b32 v108, v100
    v_mov_b32 v109, v100
    v_mov_b32 v110, v100
    v_mov_b32 v111, v100
    v_mov_b32 v112, v100
    v_mov_b32 v113, v100
    v_mov_b32 v114, v100
    v_mov_b32 v115, v100
    v_mov_b32 v48, 0
    v_mov_b32 v49, 0
    v_mov_b32 v50, 0
    v_mov_b32 v51, 0
    v_mov_b32 v52, 0
    v_mov_b32 v53, 0
    v_mov_b32 v54, 0
    v_mov_b32 v55, 0
    v_mov_b32 v56, 0
    v_mov_b32 v57, 0
    v_mov_b32 v58, 0
    v_mov_b32 v59, 0
    v_mov_b32 v60, 0
    v_mov_b32 v61, 0
    v_mov_b32 v62, 0
    v_mov_b32 v63, 0
    s_mov_b32 s52, 0x200000
    s_mul_i32 s59, s36, 4194304
    s_add_u32 s52, s52, s59
    s_mul_i32 s59, s47, 131072
    s_add_u32 s52, s52, s59
    s_mov_b32 s61, 0
L_slow2_72:
    buffer_load_dwordx4 v[68:71], v1, s[4:7], s52 offen sc1
    s_mov_b64 exec, s[62:63]
    buffer_load_dwordx4 v[76:79], v1, s[4:7], s52 offen offset:1024 sc1
    buffer_load_dwordx4 v[80:83], v1, s[4:7], s52 offen offset:1280 sc1
    s_mov_b64 exec, -1
    s_waitcnt vmcnt(0)
    v_mfma_f32_32x32x16_bf16 v[16:31], v[68:71], v[64:67], v[100:115]
    s_nop 15
    v_exp_f32 v16, v16
    v_exp_f32 v17, v17
    v_exp_f32 v18, v18
    v_exp_f32 v19, v19
    v_exp_f32 v20, v20
    v_exp_f32 v21, v21
    v_exp_f32 v22, v22
    v_exp_f32 v23, v23
    v_exp_f32 v24, v24
    v_exp_f32 v25, v25
    v_exp_f32 v26, v26
    v_exp_f32 v27, v27
    v_exp_f32 v28, v28
    v_exp_f32 v29, v29
    v_exp_f32 v30, v30
    v_exp_f32 v31, v31
    s_nop 1
    v_smfmac_f32_32x32x32_bf16 v[48:63], v[76:79], v[16:23], v92
    v_smfmac_f32_32x32x32_bf16 v[48:63], v[80:83], v[24:31], v92
    s_nop 15
    s_add_u32 s52, s52, 2048
    s_add_u32 s61, s61, 1
    s_cmp_lt_u32 s61, 64
    s_cbranch_scc1 L_slow2_72
    s_branch L_att_fin_64
L_wt_77:
    buffer_store_dwordx4 v[8:11], v1, s[4:7], s54 offen sc1
    buffer_store_dwordx4 v[12:15], v1, s[4:7], s54 offen offset:1024 sc1
    s_branch L_wtd_78
L_wt_79:
    buffer_store_dword v20, v1, s[4:7], s55 offen sc1
    s_branch L_wtd_80
L_wt_81:
    buffer_store_dwordx2 v[2:3], off, s[4:7], s56 sc1
    s_branch L_wtd_82
L_f1_idle_91:
    s_barrier
    s_barrier
    s_barrier
    s_barrier
    s_branch L_f1_setup_92
L_wt_95:
    buffer_store_dwordx4 v[192:195], v1, s[4:7], s54 offen offset:0 sc1
    buffer_store_dwordx4 v[196:199], v1, s[4:7], s54 offen offset:1024 sc1
    s_branch L_wtd_96
L_wt_97:
    buffer_store_dwordx4 v[200:203], v1, s[4:7], s54 offen offset:2048 sc1
    buffer_store_dwordx4 v[204:207], v1, s[4:7], s54 offen offset:3072 sc1
    s_branch L_wtd_98
L_wt_99:
    buffer_store_dwordx4 v[208:211], v1, s[4:7], s55 offen offset:0 sc1
    buffer_store_dwordx4 v[212:215], v1, s[4:7], s55 offen offset:1024 sc1
    s_branch L_wtd_100
L_wt_101:
    buffer_store_dwordx2 v[2:3], off, s[4:7], s56 sc1
    s_branch L_wtd_102
L_wt_115:
    buffer_store_dwordx4 v[8:11], v1, s[4:7], s54 offen sc1
    buffer_store_dwordx4 v[12:15], v1, s[4:7], s54 offen offset:1024 sc1
    s_branch L_wtd_116
L_wt_117:
    buffer_store_dword v20, v1, s[4:7], s55 offen sc1
    s_branch L_wtd_118
L_wt_119:
    buffer_store_dwordx2 v[2:3], off, s[4:7], s56 sc1
    s_branch L_wtd_120
.section .rodata,"a"
.p2align 6
.amdhsa_kernel interleave_layers__softmax_full_mha__mixer_channel_mlp__prompt_kernel
  .amdhsa_next_free_vgpr 256
  .amdhsa_next_free_sgpr 102
  .amdhsa_accum_offset 256
  .amdhsa_group_segment_fixed_size 0
  .amdhsa_kernarg_size 88
  .amdhsa_user_sgpr_count 2
  .amdhsa_user_sgpr_kernarg_segment_ptr 1
  .amdhsa_system_sgpr_workgroup_id_x 1
.end_amdhsa_kernel
```
